```python
import torch

def _softmax(x, axis=-1):
    return torch.softmax(x, dim=axis)
def _gelu(x):
    return torch.nn.functional.gelu(x, approximate="tanh")
def _silu(x):
    return torch.nn.functional.silu(x)
def _sigmoid(x):
    return torch.sigmoid(x)
def _layernorm(x, axis=-1, eps=1e-5):
    m = x.mean(dim=axis, keepdim=True)
    v = x.var(dim=axis, keepdim=True, unbiased=False)
    return (x - m) / torch.sqrt(v + eps)
def _scatter_add(tgt, idx, src, axis=0):
    return tgt.clone().index_add_(axis, idx, src)
def _segment_sum(src, seg, n):
    out = torch.zeros((n,) + src.shape[1:], dtype=src.dtype)
    return out.index_add_(0, seg, src)
def _pad(x, pw):
    flat = tuple(v for pair in reversed(pw) for v in pair)
    return torch.nn.functional.pad(x, flat)

kernel_name = 'gated_mix__sliding_block_cached__dense_activation_relu__decode'

def setup_inputs():

    _w = (lambda a: (lambda t: t.to(torch.bfloat16) if t.is_floating_point() else t)(torch.as_tensor(a)))
    def _A_setup():
        B, Sq, D = 8, 1, 1024
        Hq, Hkv, Sk, Dh = 32, 4, 4096, 128
        assert Hq % Hkv == 0, (Hq, Hkv)
        return {
            "x": _w((lambda *s: torch.randn(*s, dtype=torch.bfloat16) * 0.05)(B, Sq, D)),
            "k_cache": _w((lambda *s: torch.randn(*s, dtype=torch.bfloat16) * 6.4)(B, Hkv, Sk, Dh)),
            "v_cache": _w((lambda *s: torch.randn(*s, dtype=torch.bfloat16) * 0.4)(B, Hkv, Sk, Dh)),
            "wq": _w((lambda *s: torch.randn(*s, dtype=torch.bfloat16) * 6.4)(D, Hq * Dh) * (D ** -0.5)),
            "wo": _w((lambda *s: torch.randn(*s, dtype=torch.bfloat16) * 0.4)(Hq * Dh, D) * ((Hq * Dh) ** -0.5)),
        }
    _A_in = _A_setup()

    def _B_setup():
        B, S, D, Dff = 8, 1, 1024, 3584
        return {
            "x": _w((lambda *s: torch.randn(*s, dtype=torch.bfloat16) * 0.05)(B, S, D)),
            "w1": _w((lambda *s: torch.randn(*s, dtype=torch.bfloat16) * 0.05)(D, Dff)),
            "w2": _w((lambda *s: torch.randn(*s, dtype=torch.bfloat16) * 0.05)(Dff, D)),
        }
    _B_in = _B_setup()

    return {
        "A_x": _A_in["x"],
        "A_k_cache": _A_in["k_cache"],
        "A_v_cache": _A_in["v_cache"],
        "A_wq": _A_in["wq"],
        "A_wo": _A_in["wo"],
        "B_x": _B_in["x"],
        "B_w1": _B_in["w1"],
        "B_w2": _B_in["w2"],
        "gate_w": _w((lambda *s: torch.randn(*s, dtype=torch.bfloat16) * 0.05)(1024) * 16.0),
    }

def reference(A_x, A_k_cache, A_v_cache, A_wq, A_wo, B_x, B_w1, B_w2, gate_w):
    def _A_ref(x, k_cache, v_cache, wq, wo):
        B, Sq, D = x.shape
        Hq, Dh = 32, 128
        Hkv, Sk = k_cache.shape[1], k_cache.shape[2]
        W = min(4096, max(256, Sk // 4))
        rep = Hq // Hkv
        q = (lambda x, *d: x.permute(*d))((x @ wq).reshape(B, Sq, Hq, Dh), 0, 2, 1, 3)
        k = (lambda x, n, axis: torch.repeat_interleave(x, n, dim=axis))(k_cache[:, :, Sk - W:, :], rep, axis=1)
        v = (lambda x, n, axis: torch.repeat_interleave(x, n, dim=axis))(v_cache[:, :, Sk - W:, :], rep, axis=1)
        scores = torch.einsum("bhqd,bhkd->bhqk", q, k) * (Dh ** -0.5)
        p = _softmax(scores, axis=-1)
        o = torch.einsum("bhqk,bhkd->bhqd", p, v)
        return (lambda x, *d: x.permute(*d))(o, 0, 2, 1, 3).reshape(B, Sq, Hq * Dh) @ wo

    def _B_ref(x, w1, w2):
        h = torch.einsum("bsd,df->bsf", x, w1)
        zero = torch.zeros_like(h)
        h = torch.maximum(h, zero)
        return torch.einsum("bsf,fd->bsd", h, w2)

    x = A_x
    g = _sigmoid((x * gate_w).sum(-1, keepdims=True))
    a = _A_ref(x, A_k_cache, A_v_cache, A_wq, A_wo)
    b = _B_ref(x, B_w1, B_w2)
    return g * a + (1 - g) * b
```

```asm
; @launch grid=(256,1,1) block=(832,1,1) lds=158032
.amdgcn_target "amdgcn-amd-amdhsa--gfx950"
.text
.globl gated_mix__sliding_block_cached__dense_activation_relu__decode_kernel
.p2align 8
.type gated_mix__sliding_block_cached__dense_activation_relu__decode_kernel,@function
gated_mix__sliding_block_cached__dense_activation_relu__decode_kernel:
    s_load_dwordx2 s[16:17], s[0:1], 24
    s_load_dwordx2 s[4:5], s[0:1], 0
    s_load_dwordx16 s[84:99], s[0:1], 0
    s_load_dwordx8 s[76:83], s[0:1], 64
    s_cmp_ge_u32 s2, 256
    s_cbranch_scc1 L_end
    v_lshrrev_b32 v7, 6, v0
    v_and_b32 v16, 63, v0
    v_readfirstlane_b32 s3, v7
    v_mov_b32 v4, 131072
    s_cmp_lg_u32 s3, 1
    s_cbranch_scc1 L_b0
    s_getpc_b64 s[58:59]
    v_lshlrev_b32 v7, 7, v16
    global_load_dword v126, v7, s[58:59]
    v_add_u32 v7, 8192, v7
    s_mov_b32 exec_hi, 0xffff
    global_load_dword v127, v7, s[58:59]
    s_mov_b64 exec, 0x1ff
    v_mov_b32 v20, 0
    v_mov_b32 v21, 0
    v_mov_b32 v22, 0
    v_mov_b32 v23, 0
    v_lshl_add_u32 v7, v16, 4, v4
    ds_write_b128 v7, v[20:23] offset:18368
    s_mov_b64 exec, -1
L_b0:
    s_and_b32 s48, s2, 7
    s_lshr_b32 s49, s2, 3
    s_lshr_b32 s51, s2, 6
    s_lshr_b32 s54, s48, 2
    s_lshl_b32 s54, s54, 1
    s_lshr_b32 s56, s2, 7
    s_add_u32 s54, s54, s56
    s_mul_i32 s72, s48, 1
    s_mul_i32 s56, s51, 2
    s_add_u32 s72, s72, s56
    s_and_b32 s72, s72, 7
    s_and_b32 s60, s48, 3
    s_and_b32 s61, s49, 15
    v_lshrrev_b32 v2, 4, v16
    v_and_b32 v3, 15, v0
    s_cmp_eq_u32 s3, 0
    s_cbranch_scc1 L_loader
    s_lshl_b32 s57, s2, 12
    s_mul_i32 s58, s3, 1024
    s_add_u32 s57, s57, s58
    s_add_u32 s57, s57, 3135488
    s_waitcnt lgkmcnt(0)
    s_load_dword s44, s[82:83], 0
    s_cmp_lt_u32 s3, 10
    s_cbranch_scc1 L_npt
    s_load_dword s45, s[82:83], s57 glc
L_npt:
    s_barrier
    s_branch L_notloader
L_loader:
    s_setprio 3
    v_lshrrev_b32 v17, 3, v16
    v_lshlrev_b32 v18, 1, v2
    v_and_b32 v19, 7, v16
    v_xor_b32 v19, v19, v18
    v_lshlrev_b32 v19, 4, v19
    v_lshl_add_u32 v32, v17, 13, v19
    v_add_u32 v33, 64512, v32
    v_add_u32 v34, 129024, v32
    v_add_u32 v35, 193536, v32
    s_lshl_b32 s56, s60, 4
    s_add_u32 s56, s56, s61
    s_lshl_b32 s56, s56, 7
    s_lshl_b32 s44, s54, 21
    s_add_u32 s44, s44, s56
    s_mov_b32 s18, 8388608
    s_mov_b32 s19, 0x20000
    s_waitcnt lgkmcnt(0)
    s_add_u32 s57, s72, 0
    s_and_b32 s57, s57, 7
    s_lshl_b32 s57, s57, 18
    s_mov_b32 m0, 0
    s_add_u32 s57, s57, s44
    buffer_load_dwordx4 v32, s[16:19], s57 offen offset:0 nt lds
    buffer_load_dwordx4 v33, s[16:19], s57 offen offset:1024 nt lds
    buffer_load_dwordx4 v34, s[16:19], s57 offen offset:2048 nt lds
    buffer_load_dwordx4 v35, s[16:19], s57 offen offset:3072 nt lds
    s_add_u32 s57, s72, 1
    s_and_b32 s57, s57, 7
    s_lshl_b32 s57, s57, 18
    s_mov_b32 m0, 4096
    s_add_u32 s57, s57, s44
    buffer_load_dwordx4 v32, s[16:19], s57 offen offset:0 nt lds
    buffer_load_dwordx4 v33, s[16:19], s57 offen offset:1024 nt lds
    buffer_load_dwordx4 v34, s[16:19], s57 offen offset:2048 nt lds
    buffer_load_dwordx4 v35, s[16:19], s57 offen offset:3072 nt lds
    v_lshrrev_b32 v21, 1, v2
    v_and_b32 v22, 31, v16
    v_xor_b32 v22, v22, v21
    s_lshl_b32 s57, s72, 2
    v_lshlrev_b32 v21, 11, v21
    v_xor_b32 v52, 0, v22
    v_add_u32 v52, s57, v52
    v_and_b32 v52, 31, v52
    v_lshl_add_u32 v52, v52, 4, v21
    v_xor_b32 v53, 2, v22
    v_add_u32 v53, s57, v53
    v_and_b32 v53, 31, v53
    v_lshl_add_u32 v53, v53, 4, v21
    v_add_u32 v53, 3072, v53
    v_xor_b32 v54, 4, v22
    v_add_u32 v54, s57, v54
    v_and_b32 v54, 31, v54
    v_lshl_add_u32 v54, v54, 4, v21
    v_add_u32 v54, 6144, v54
    v_xor_b32 v55, 6, v22
    v_add_u32 v55, s57, v55
    v_and_b32 v55, 31, v55
    v_lshl_add_u32 v55, v55, 4, v21
    v_add_u32 v55, 9216, v55
    s_mov_b32 m0, 131072
    s_mov_b32 s6, 16384
    s_mov_b32 s7, 0x20000
    s_lshl_b32 s58, s54, 9
    buffer_load_dwordx4 v52, s[4:7], s58 offen offset:0 lds
    buffer_load_dwordx4 v53, s[4:7], s58 offen offset:1024 lds
    buffer_load_dwordx4 v54, s[4:7], s58 offen offset:2048 lds
    buffer_load_dwordx4 v55, s[4:7], s58 offen offset:3072 lds
    s_add_u32 s57, s72, 2
    s_and_b32 s57, s57, 7
    s_lshl_b32 s57, s57, 18
    s_mov_b32 m0, 8192
    s_add_u32 s57, s57, s44
    buffer_load_dwordx4 v32, s[16:19], s57 offen offset:0 nt lds
    buffer_load_dwordx4 v33, s[16:19], s57 offen offset:1024 nt lds
    buffer_load_dwordx4 v34, s[16:19], s57 offen offset:2048 nt lds
    buffer_load_dwordx4 v35, s[16:19], s57 offen offset:3072 nt lds
    s_add_u32 s57, s72, 3
    s_and_b32 s57, s57, 7
    s_lshl_b32 s57, s57, 18
    s_mov_b32 m0, 12288
    s_add_u32 s57, s57, s44
    buffer_load_dwordx4 v32, s[16:19], s57 offen offset:0 nt lds
    buffer_load_dwordx4 v33, s[16:19], s57 offen offset:1024 nt lds
    buffer_load_dwordx4 v34, s[16:19], s57 offen offset:2048 nt lds
    buffer_load_dwordx4 v35, s[16:19], s57 offen offset:3072 nt lds
    s_add_u32 s57, s72, 4
    s_and_b32 s57, s57, 7
    s_lshl_b32 s57, s57, 18
    s_mov_b32 m0, 16384
    s_add_u32 s57, s57, s44
    buffer_load_dwordx4 v32, s[16:19], s57 offen offset:0 nt lds
    buffer_load_dwordx4 v33, s[16:19], s57 offen offset:1024 nt lds
    buffer_load_dwordx4 v34, s[16:19], s57 offen offset:2048 nt lds
    buffer_load_dwordx4 v35, s[16:19], s57 offen offset:3072 nt lds
    s_add_u32 s57, s72, 5
    s_and_b32 s57, s57, 7
    s_lshl_b32 s57, s57, 18
    s_mov_b32 m0, 20480
    s_add_u32 s57, s57, s44
    buffer_load_dwordx4 v32, s[16:19], s57 offen offset:0 nt lds
    buffer_load_dwordx4 v33, s[16:19], s57 offen offset:1024 nt lds
    buffer_load_dwordx4 v34, s[16:19], s57 offen offset:2048 nt lds
    buffer_load_dwordx4 v35, s[16:19], s57 offen offset:3072 nt lds
    s_add_u32 s57, s72, 6
    s_and_b32 s57, s57, 7
    s_lshl_b32 s57, s57, 18
    s_mov_b32 m0, 24576
    s_add_u32 s57, s57, s44
    buffer_load_dwordx4 v32, s[16:19], s57 offen offset:0 nt lds
    buffer_load_dwordx4 v33, s[16:19], s57 offen offset:1024 nt lds
    buffer_load_dwordx4 v34, s[16:19], s57 offen offset:2048 nt lds
    buffer_load_dwordx4 v35, s[16:19], s57 offen offset:3072 nt lds
    s_add_u32 s57, s72, 7
    s_and_b32 s57, s57, 7
    s_lshl_b32 s57, s57, 18
    s_mov_b32 m0, 28672
    s_add_u32 s57, s57, s44
    buffer_load_dwordx4 v32, s[16:19], s57 offen offset:0 nt lds
    buffer_load_dwordx4 v33, s[16:19], s57 offen offset:1024 nt lds
    buffer_load_dwordx4 v34, s[16:19], s57 offen offset:2048 nt lds
    buffer_load_dwordx4 v35, s[16:19], s57 offen offset:3072 nt lds
    s_barrier
    s_mov_b32 s8, s86
    s_mov_b32 s9, s87
    s_mov_b32 s10, 33554432
    s_mov_b32 s11, 0x20000
    s_mov_b32 s12, s88
    s_mov_b32 s13, s89
    s_mov_b32 s14, 33554432
    s_mov_b32 s15, 0x20000
    s_mov_b32 s20, s92
    s_mov_b32 s21, s93
    s_mov_b32 s22, 8388608
    s_mov_b32 s23, 0x20000
    s_mov_b32 s24, s96
    s_mov_b32 s25, s97
    s_mov_b32 s27, 0x20000
    s_mov_b32 s28, s98
    s_mov_b32 s29, s99
    s_mov_b32 s31, 0x20000
    s_mul_i32 s50, s48, 1
    s_mul_i32 s56, s51, 2
    s_add_u32 s50, s50, s56
    s_and_b32 s50, s50, 7
    s_and_b32 s52, s49, 7
    s_lshl_b32 s53, s48, 2
    s_add_u32 s53, s53, s51
    s_mul_i32 s59, s60, 14
    s_add_u32 s59, s59, s61
    s_cmp_gt_u32 s61, 3
    s_subb_u32 s59, s59, 0
    s_cmp_gt_u32 s61, 11
    s_subb_u32 s59, s59, 0
    s_cmp_lg_u32 s52, 3
    s_cselect_b32 s67, 1, 0
    s_mul_i32 s69, s48, 3
    s_add_u32 s69, s69, s51
    s_lshr_b32 s56, s48, 1
    s_add_u32 s56, s56, 24
    s_xor_b32 s57, s48, s52
    s_and_b32 s57, s57, 1
    s_cmp_eq_u32 s51, 3
    s_cselect_b32 s69, s56, s69
    s_cselect_b32 s68, s57, 1
    s_mul_i32 s73, s48, 1
    s_mul_i32 s56, s51, 2
    s_add_u32 s73, s73, s56
    s_and_b32 s73, s73, 7
    s_cmp_eq_u32 s67, 1
    s_cselect_b32 s26, 7340032, 0
    s_cmp_eq_u32 s68, 1
    s_cselect_b32 s30, 7340032, 0
    s_mul_i32 s46, s54, 1835008
    s_lshl_b32 s56, s59, 7
    s_add_u32 s46, s46, s56
    s_lshl_b32 s45, s53, 20
    s_lshl_b32 s56, s52, 15
    s_add_u32 s45, s45, s56
    s_add_u32 s45, s45, 786432
    s_lshl_b32 s56, s52, 8
    s_lshl_b32 s47, s53, 18
    s_add_u32 s47, s47, s56
    s_lshl_b32 s65, s69, 18
    s_add_u32 s65, s65, s56
    v_mul_u32_u24 v36, 7168, v17
    v_add_u32 v36, v36, v19
    v_add_u32 v37, 56320, v36
    v_add_u32 v38, 112640, v36
    v_add_u32 v39, 168960, v36
    v_xor_b32 v20, v3, v2
    v_lshlrev_b32 v20, 4, v20
    v_lshl_add_u32 v40, v2, 8, v20
    v_xor_b32 v41, 64, v40
    v_xor_b32 v42, 128, v40
    v_xor_b32 v43, 192, v40
    v_xor_b32 v20, v3, v18
    v_lshlrev_b32 v20, 4, v20
    v_lshl_add_u32 v44, v2, 8, v20
    v_xor_b32 v45, 128, v44
    v_mov_b32 v46, v44
    v_mov_b32 v47, v45
    v_lshl_add_u32 v48, v2, 11, v20
    v_xor_b32 v49, 128, v48
    v_add_u32 v50, 14336, v48
    v_add_u32 v51, 21504, v49
    v_add_u32 v49, 7168, v49
    s_waitcnt vmcnt(24)
    s_mov_b64 exec, 1
    v_mov_b32 v8, 1
    ds_write_b32 v4, v8 offset:18384
    s_mov_b64 exec, -1
    s_add_u32 s57, s73, 0
    s_and_b32 s57, s57, 7
    s_lshl_b32 s57, s57, 12
    s_mov_b32 m0, 32768
    s_add_u32 s57, s57, s45
    s_waitcnt vmcnt(21)
    buffer_load_dwordx4 v40, s[8:11], s57 offen offset:0 nt lds
    s_waitcnt vmcnt(21)
    buffer_load_dwordx4 v41, s[8:11], s57 offen offset:1024 nt lds
    s_waitcnt vmcnt(21)
    buffer_load_dwordx4 v42, s[8:11], s57 offen offset:2048 nt lds
    s_waitcnt vmcnt(21)
    buffer_load_dwordx4 v43, s[8:11], s57 offen offset:3072 nt lds
    s_add_u32 s57, s73, 1
    s_and_b32 s57, s57, 7
    s_lshl_b32 s57, s57, 12
    s_mov_b32 m0, 36864
    s_add_u32 s57, s57, s45
    s_waitcnt vmcnt(21)
    buffer_load_dwordx4 v40, s[8:11], s57 offen offset:0 nt lds
    s_waitcnt vmcnt(21)
    buffer_load_dwordx4 v41, s[8:11], s57 offen offset:1024 nt lds
    s_waitcnt vmcnt(21)
    buffer_load_dwordx4 v42, s[8:11], s57 offen offset:2048 nt lds
    s_waitcnt vmcnt(21)
    buffer_load_dwordx4 v43, s[8:11], s57 offen offset:3072 nt lds
    s_add_u32 s57, s73, 2
    s_and_b32 s57, s57, 7
    s_lshl_b32 s57, s57, 12
    s_mov_b32 m0, 40960
    s_add_u32 s57, s57, s45
    s_waitcnt vmcnt(21)
    buffer_load_dwordx4 v40, s[8:11], s57 offen offset:0 nt lds
    s_waitcnt vmcnt(21)
    s_mov_b64 exec, 1
    v_mov_b32 v8, 5
    ds_write_b32 v4, v8 offset:18368
    s_mov_b64 exec, -1
    buffer_load_dwordx4 v41, s[8:11], s57 offen offset:1024 nt lds
    s_waitcnt vmcnt(21)
    buffer_load_dwordx4 v42, s[8:11], s57 offen offset:2048 nt lds
    s_waitcnt vmcnt(21)
    buffer_load_dwordx4 v43, s[8:11], s57 offen offset:3072 nt lds
    s_add_u32 s57, s73, 3
    s_and_b32 s57, s57, 7
    s_lshl_b32 s57, s57, 12
    s_mov_b32 m0, 45056
    s_add_u32 s57, s57, s45
    s_waitcnt vmcnt(21)
    buffer_load_dwordx4 v40, s[8:11], s57 offen offset:0 nt lds
    s_waitcnt vmcnt(21)
    s_mov_b64 exec, 1
    v_mov_b32 v8, 6
    ds_write_b32 v4, v8 offset:18368
    s_mov_b64 exec, -1
    buffer_load_dwordx4 v41, s[8:11], s57 offen offset:1024 nt lds
    s_waitcnt vmcnt(21)
    buffer_load_dwordx4 v42, s[8:11], s57 offen offset:2048 nt lds
    s_waitcnt vmcnt(21)
    buffer_load_dwordx4 v43, s[8:11], s57 offen offset:3072 nt lds
    s_add_u32 s57, s73, 4
    s_and_b32 s57, s57, 7
    s_lshl_b32 s57, s57, 12
    s_mov_b32 m0, 49152
    s_add_u32 s57, s57, s45
    s_waitcnt vmcnt(21)
    buffer_load_dwordx4 v40, s[8:11], s57 offen offset:0 nt lds
    s_waitcnt vmcnt(21)
    s_mov_b64 exec, 1
    v_mov_b32 v8, 7
    ds_write_b32 v4, v8 offset:18368
    s_mov_b64 exec, -1
    buffer_load_dwordx4 v41, s[8:11], s57 offen offset:1024 nt lds
    s_waitcnt vmcnt(21)
    buffer_load_dwordx4 v42, s[8:11], s57 offen offset:2048 nt lds
    s_waitcnt vmcnt(21)
    buffer_load_dwordx4 v43, s[8:11], s57 offen offset:3072 nt lds
    s_add_u32 s57, s73, 5
    s_and_b32 s57, s57, 7
    s_lshl_b32 s57, s57, 12
    s_mov_b32 m0, 53248
    s_add_u32 s57, s57, s45
    s_waitcnt vmcnt(21)
    buffer_load_dwordx4 v40, s[8:11], s57 offen offset:0 nt lds
    s_waitcnt vmcnt(21)
    s_mov_b64 exec, 1
    v_mov_b32 v8, 8
    ds_write_b32 v4, v8 offset:18368
    s_mov_b64 exec, -1
    buffer_load_dwordx4 v41, s[8:11], s57 offen offset:1024 nt lds
    s_waitcnt vmcnt(21)
    buffer_load_dwordx4 v42, s[8:11], s57 offen offset:2048 nt lds
    s_waitcnt vmcnt(21)
    buffer_load_dwordx4 v43, s[8:11], s57 offen offset:3072 nt lds
    s_add_u32 s57, s73, 6
    s_and_b32 s57, s57, 7
    s_lshl_b32 s57, s57, 12
    s_mov_b32 m0, 57344
    s_add_u32 s57, s57, s45
    s_waitcnt vmcnt(21)
    buffer_load_dwordx4 v40, s[8:11], s57 offen offset:0 nt lds
    s_waitcnt vmcnt(21)
    s_mov_b64 exec, 1
    v_mov_b32 v8, 9
    ds_write_b32 v4, v8 offset:18368
    s_mov_b64 exec, -1
    buffer_load_dwordx4 v41, s[8:11], s57 offen offset:1024 nt lds
    s_waitcnt vmcnt(21)
    buffer_load_dwordx4 v42, s[8:11], s57 offen offset:2048 nt lds
    s_waitcnt vmcnt(21)
    buffer_load_dwordx4 v43, s[8:11], s57 offen offset:3072 nt lds
    s_add_u32 s57, s73, 7
    s_and_b32 s57, s57, 7
    s_lshl_b32 s57, s57, 12
    s_mov_b32 m0, 61440
    s_add_u32 s57, s57, s45
    s_waitcnt vmcnt(21)
    buffer_load_dwordx4 v40, s[8:11], s57 offen offset:0 nt lds
    s_waitcnt vmcnt(21)
    s_mov_b64 exec, 1
    v_mov_b32 v8, 10
    ds_write_b32 v4, v8 offset:18368
    s_mov_b64 exec, -1
    buffer_load_dwordx4 v41, s[8:11], s57 offen offset:1024 nt lds
    s_waitcnt vmcnt(21)
    buffer_load_dwordx4 v42, s[8:11], s57 offen offset:2048 nt lds
    s_waitcnt vmcnt(21)
    buffer_load_dwordx4 v43, s[8:11], s57 offen offset:3072 nt lds
    s_add_u32 s57, s73, 0
    s_and_b32 s57, s57, 7
    s_lshl_b32 s57, s57, 12
    s_mov_b32 m0, 65536
    s_add_u32 s57, s57, s45
    s_waitcnt vmcnt(21)
    buffer_load_dwordx4 v44, s[12:15], s57 offen offset:0 nt lds
    s_waitcnt vmcnt(21)
    s_mov_b64 exec, 1
    v_mov_b32 v8, 11
    ds_write_b32 v4, v8 offset:18368
    s_mov_b64 exec, -1
    buffer_load_dwordx4 v45, s[12:15], s57 offen offset:1024 nt lds
    s_waitcnt vmcnt(21)
    buffer_load_dwordx4 v46, s[12:15], s57 offen offset:2048 nt lds
    s_waitcnt vmcnt(21)
    buffer_load_dwordx4 v47, s[12:15], s57 offen offset:3072 nt lds
    s_add_u32 s57, s73, 1
    s_and_b32 s57, s57, 7
    s_lshl_b32 s57, s57, 12
    s_mov_b32 m0, 69632
    s_add_u32 s57, s57, s45
    s_waitcnt vmcnt(21)
    buffer_load_dwordx4 v44, s[12:15], s57 offen offset:0 nt lds
    s_waitcnt vmcnt(21)
    s_mov_b64 exec, 1
    v_mov_b32 v8, 12
    ds_write_b32 v4, v8 offset:18368
    s_mov_b64 exec, -1
    buffer_load_dwordx4 v45, s[12:15], s57 offen offset:1024 nt lds
    s_waitcnt vmcnt(21)
    buffer_load_dwordx4 v46, s[12:15], s57 offen offset:2048 nt lds
    s_waitcnt vmcnt(21)
    buffer_load_dwordx4 v47, s[12:15], s57 offen offset:3072 nt lds
    s_add_u32 s57, s73, 2
    s_and_b32 s57, s57, 7
    s_lshl_b32 s57, s57, 12
    s_mov_b32 m0, 73728
    s_add_u32 s57, s57, s45
    s_waitcnt vmcnt(21)
    buffer_load_dwordx4 v44, s[12:15], s57 offen offset:0 nt lds
    s_waitcnt vmcnt(21)
    s_mov_b64 exec, 1
    v_mov_b32 v8, 13
    ds_write_b32 v4, v8 offset:18368
    s_mov_b64 exec, -1
    buffer_load_dwordx4 v45, s[12:15], s57 offen offset:1024 nt lds
    s_waitcnt vmcnt(21)
    buffer_load_dwordx4 v46, s[12:15], s57 offen offset:2048 nt lds
    s_waitcnt vmcnt(21)
    buffer_load_dwordx4 v47, s[12:15], s57 offen offset:3072 nt lds
    s_add_u32 s57, s73, 3
    s_and_b32 s57, s57, 7
    s_lshl_b32 s57, s57, 12
    s_mov_b32 m0, 77824
    s_add_u32 s57, s57, s45
    s_waitcnt vmcnt(21)
    buffer_load_dwordx4 v44, s[12:15], s57 offen offset:0 nt lds
    s_waitcnt vmcnt(21)
    s_mov_b64 exec, 1
    v_mov_b32 v8, 14
    ds_write_b32 v4, v8 offset:18368
    s_mov_b64 exec, -1
    buffer_load_dwordx4 v45, s[12:15], s57 offen offset:1024 nt lds
    s_waitcnt vmcnt(21)
    buffer_load_dwordx4 v46, s[12:15], s57 offen offset:2048 nt lds
    s_waitcnt vmcnt(21)
    buffer_load_dwordx4 v47, s[12:15], s57 offen offset:3072 nt lds
    s_add_u32 s57, s73, 4
    s_and_b32 s57, s57, 7
    s_lshl_b32 s57, s57, 12
    s_mov_b32 m0, 81920
    s_add_u32 s57, s57, s45
    s_waitcnt vmcnt(21)
    buffer_load_dwordx4 v44, s[12:15], s57 offen offset:0 nt lds
    s_waitcnt vmcnt(21)
    s_mov_b64 exec, 1
    v_mov_b32 v8, 15
    ds_write_b32 v4, v8 offset:18368
    s_mov_b64 exec, -1
    buffer_load_dwordx4 v45, s[12:15], s57 offen offset:1024 nt lds
    s_waitcnt vmcnt(21)
    buffer_load_dwordx4 v46, s[12:15], s57 offen offset:2048 nt lds
    s_waitcnt vmcnt(21)
    buffer_load_dwordx4 v47, s[12:15], s57 offen offset:3072 nt lds
    s_add_u32 s57, s73, 5
    s_and_b32 s57, s57, 7
    s_lshl_b32 s57, s57, 12
    s_mov_b32 m0, 86016
    s_add_u32 s57, s57, s45
    s_waitcnt vmcnt(21)
    buffer_load_dwordx4 v44, s[12:15], s57 offen offset:0 nt lds
    s_waitcnt vmcnt(21)
    s_mov_b64 exec, 1
    v_mov_b32 v8, 16
    ds_write_b32 v4, v8 offset:18368
    s_mov_b64 exec, -1
    buffer_load_dwordx4 v45, s[12:15], s57 offen offset:1024 nt lds
    s_waitcnt vmcnt(21)
    buffer_load_dwordx4 v46, s[12:15], s57 offen offset:2048 nt lds
    s_waitcnt vmcnt(21)
    buffer_load_dwordx4 v47, s[12:15], s57 offen offset:3072 nt lds
    s_add_u32 s57, s73, 6
    s_and_b32 s57, s57, 7
    s_lshl_b32 s57, s57, 12
    s_mov_b32 m0, 90112
    s_add_u32 s57, s57, s45
    s_waitcnt vmcnt(21)
    buffer_load_dwordx4 v44, s[12:15], s57 offen offset:0 nt lds
    s_waitcnt vmcnt(21)
    s_mov_b64 exec, 1
    v_mov_b32 v8, 17
    ds_write_b32 v4, v8 offset:18368
    s_mov_b64 exec, -1
    buffer_load_dwordx4 v45, s[12:15], s57 offen offset:1024 nt lds
    s_waitcnt vmcnt(21)
    buffer_load_dwordx4 v46, s[12:15], s57 offen offset:2048 nt lds
    s_waitcnt vmcnt(21)
    buffer_load_dwordx4 v47, s[12:15], s57 offen offset:3072 nt lds
    s_add_u32 s57, s73, 7
    s_and_b32 s57, s57, 7
    s_lshl_b32 s57, s57, 12
    s_mov_b32 m0, 94208
    s_add_u32 s57, s57, s45
    s_waitcnt vmcnt(21)
    buffer_load_dwordx4 v44, s[12:15], s57 offen offset:0 nt lds
    s_waitcnt vmcnt(21)
    s_mov_b64 exec, 1
    v_mov_b32 v8, 18
    ds_write_b32 v4, v8 offset:18368
    s_mov_b64 exec, -1
    buffer_load_dwordx4 v45, s[12:15], s57 offen offset:1024 nt lds
    s_waitcnt vmcnt(21)
    buffer_load_dwordx4 v46, s[12:15], s57 offen offset:2048 nt lds
    s_waitcnt vmcnt(21)
    buffer_load_dwordx4 v47, s[12:15], s57 offen offset:3072 nt lds
    s_add_u32 s57, s72, 0
    s_and_b32 s57, s57, 7
    s_mul_i32 s57, s57, 229376
    s_mov_b32 m0, 98304
    s_add_u32 s57, s57, s46
    s_waitcnt vmcnt(21)
    buffer_load_dwordx4 v36, s[24:27], s57 offen offset:0 nt lds
    s_waitcnt vmcnt(21)
    s_mov_b64 exec, 1
    v_mov_b32 v8, 19
    ds_write_b32 v4, v8 offset:18368
    s_mov_b64 exec, -1
    buffer_load_dwordx4 v37, s[24:27], s57 offen offset:1024 nt lds
    s_waitcnt vmcnt(21)
    buffer_load_dwordx4 v38, s[24:27], s57 offen offset:2048 nt lds
    s_waitcnt vmcnt(21)
    buffer_load_dwordx4 v39, s[24:27], s57 offen offset:3072 nt lds
    s_add_u32 s57, s72, 1
    s_and_b32 s57, s57, 7
    s_mul_i32 s57, s57, 229376
    s_mov_b32 m0, 102400
    s_add_u32 s57, s57, s46
    s_waitcnt vmcnt(21)
    buffer_load_dwordx4 v36, s[24:27], s57 offen offset:0 nt lds
    s_waitcnt vmcnt(21)
    s_mov_b64 exec, 1
    v_mov_b32 v8, 20
    ds_write_b32 v4, v8 offset:18368
    s_mov_b64 exec, -1
    buffer_load_dwordx4 v37, s[24:27], s57 offen offset:1024 nt lds
    s_waitcnt vmcnt(21)
    buffer_load_dwordx4 v38, s[24:27], s57 offen offset:2048 nt lds
    s_waitcnt vmcnt(21)
    buffer_load_dwordx4 v39, s[24:27], s57 offen offset:3072 nt lds
    s_add_u32 s57, s72, 2
    s_and_b32 s57, s57, 7
    s_mul_i32 s57, s57, 229376
    s_mov_b32 m0, 106496
    s_add_u32 s57, s57, s46
    s_waitcnt vmcnt(21)
    buffer_load_dwordx4 v36, s[24:27], s57 offen offset:0 nt lds
    s_waitcnt vmcnt(21)
    s_mov_b64 exec, 1
    v_mov_b32 v8, 21
    ds_write_b32 v4, v8 offset:18368
    s_mov_b64 exec, -1
    buffer_load_dwordx4 v37, s[24:27], s57 offen offset:1024 nt lds
    s_waitcnt vmcnt(21)
    buffer_load_dwordx4 v38, s[24:27], s57 offen offset:2048 nt lds
    s_waitcnt vmcnt(21)
    buffer_load_dwordx4 v39, s[24:27], s57 offen offset:3072 nt lds
    s_add_u32 s57, s72, 3
    s_and_b32 s57, s57, 7
    s_mul_i32 s57, s57, 229376
    s_mov_b32 m0, 110592
    s_add_u32 s57, s57, s46
    s_waitcnt vmcnt(21)
    buffer_load_dwordx4 v36, s[24:27], s57 offen offset:0 nt lds
    s_waitcnt vmcnt(21)
    s_mov_b64 exec, 1
    v_mov_b32 v8, 22
    ds_write_b32 v4, v8 offset:18368
    s_mov_b64 exec, -1
    buffer_load_dwordx4 v37, s[24:27], s57 offen offset:1024 nt lds
    s_waitcnt vmcnt(21)
    buffer_load_dwordx4 v38, s[24:27], s57 offen offset:2048 nt lds
    s_waitcnt vmcnt(21)
    buffer_load_dwordx4 v39, s[24:27], s57 offen offset:3072 nt lds
    s_add_u32 s57, s72, 4
    s_and_b32 s57, s57, 7
    s_mul_i32 s57, s57, 229376
    s_mov_b32 m0, 114688
    s_add_u32 s57, s57, s46
    s_waitcnt vmcnt(21)
    buffer_load_dwordx4 v36, s[24:27], s57 offen offset:0 nt lds
    s_waitcnt vmcnt(21)
    s_mov_b64 exec, 1
    v_mov_b32 v8, 23
    ds_write_b32 v4, v8 offset:18368
    s_mov_b64 exec, -1
    buffer_load_dwordx4 v37, s[24:27], s57 offen offset:1024 nt lds
    s_waitcnt vmcnt(21)
    buffer_load_dwordx4 v38, s[24:27], s57 offen offset:2048 nt lds
    s_waitcnt vmcnt(21)
    buffer_load_dwordx4 v39, s[24:27], s57 offen offset:3072 nt lds
    s_add_u32 s57, s72, 5
    s_and_b32 s57, s57, 7
    s_mul_i32 s57, s57, 229376
    s_mov_b32 m0, 118784
    s_add_u32 s57, s57, s46
    s_waitcnt vmcnt(21)
    buffer_load_dwordx4 v36, s[24:27], s57 offen offset:0 nt lds
    s_waitcnt vmcnt(21)
    s_mov_b64 exec, 1
    v_mov_b32 v8, 24
    ds_write_b32 v4, v8 offset:18368
    s_mov_b64 exec, -1
    buffer_load_dwordx4 v37, s[24:27], s57 offen offset:1024 nt lds
    s_waitcnt vmcnt(21)
    buffer_load_dwordx4 v38, s[24:27], s57 offen offset:2048 nt lds
    s_waitcnt vmcnt(21)
    buffer_load_dwordx4 v39, s[24:27], s57 offen offset:3072 nt lds
    s_add_u32 s57, s72, 6
    s_and_b32 s57, s57, 7
    s_mul_i32 s57, s57, 229376
    s_mov_b32 m0, 122880
    s_add_u32 s57, s57, s46
    s_waitcnt vmcnt(21)
    buffer_load_dwordx4 v36, s[24:27], s57 offen offset:0 nt lds
    s_waitcnt vmcnt(21)
    s_mov_b64 exec, 1
    v_mov_b32 v8, 25
    ds_write_b32 v4, v8 offset:18368
    s_mov_b64 exec, -1
    buffer_load_dwordx4 v37, s[24:27], s57 offen offset:1024 nt lds
    s_waitcnt vmcnt(21)
    buffer_load_dwordx4 v38, s[24:27], s57 offen offset:2048 nt lds
    s_waitcnt vmcnt(21)
    buffer_load_dwordx4 v39, s[24:27], s57 offen offset:3072 nt lds
    s_add_u32 s57, s72, 7
    s_and_b32 s57, s57, 7
    s_mul_i32 s57, s57, 229376
    s_mov_b32 m0, 126976
    s_add_u32 s57, s57, s46
    s_waitcnt vmcnt(21)
    buffer_load_dwordx4 v36, s[24:27], s57 offen offset:0 nt lds
    s_waitcnt vmcnt(21)
    s_mov_b64 exec, 1
    v_mov_b32 v8, 26
    ds_write_b32 v4, v8 offset:18368
    s_mov_b64 exec, -1
    buffer_load_dwordx4 v37, s[24:27], s57 offen offset:1024 nt lds
    s_waitcnt vmcnt(21)
    buffer_load_dwordx4 v38, s[24:27], s57 offen offset:2048 nt lds
    s_waitcnt vmcnt(21)
    buffer_load_dwordx4 v39, s[24:27], s57 offen offset:3072 nt lds
    s_mov_b32 s64, 0
L_w1:
    ds_read_b32 v7, v4 offset:18376
    s_add_u32 s64, s64, 1
    s_waitcnt lgkmcnt(0)
    v_readfirstlane_b32 s56, v7
    s_cmp_ge_u32 s56, 4
    s_cbranch_scc1 L_wd2
    s_cmp_lt_u32 s64, 1000000
    s_cbranch_scc1 L_w1
L_wd2:
    s_add_u32 s57, s50, 0
    s_and_b32 s57, s57, 7
    s_lshl_b32 s57, s57, 15
    s_mov_b32 m0, 0
    s_add_u32 s57, s57, s47
    s_waitcnt vmcnt(21)
    buffer_load_dwordx4 v48, s[20:23], s57 offen offset:0 nt lds
    s_waitcnt vmcnt(21)
    s_mov_b64 exec, 1
    v_mov_b32 v8, 27
    ds_write_b32 v4, v8 offset:18368
    s_mov_b64 exec, -1
    buffer_load_dwordx4 v49, s[20:23], s57 offen offset:1024 nt lds
    s_waitcnt vmcnt(21)
    buffer_load_dwordx4 v50, s[20:23], s57 offen offset:2048 nt lds
    s_waitcnt vmcnt(21)
    buffer_load_dwordx4 v51, s[20:23], s57 offen offset:3072 nt lds
    s_add_u32 s57, s50, 1
    s_and_b32 s57, s57, 7
    s_lshl_b32 s57, s57, 15
    s_mov_b32 m0, 4096
    s_add_u32 s57, s57, s47
    s_waitcnt vmcnt(21)
    buffer_load_dwordx4 v48, s[20:23], s57 offen offset:0 nt lds
    s_waitcnt vmcnt(21)
    s_mov_b64 exec, 1
    v_mov_b32 v8, 28
    ds_write_b32 v4, v8 offset:18368
    s_mov_b64 exec, -1
    buffer_load_dwordx4 v49, s[20:23], s57 offen offset:1024 nt lds
    s_waitcnt vmcnt(21)
    buffer_load_dwordx4 v50, s[20:23], s57 offen offset:2048 nt lds
    s_waitcnt vmcnt(21)
    buffer_load_dwordx4 v51, s[20:23], s57 offen offset:3072 nt lds
    s_add_u32 s57, s50, 2
    s_and_b32 s57, s57, 7
    s_lshl_b32 s57, s57, 15
    s_mov_b32 m0, 8192
    s_add_u32 s57, s57, s47
    s_waitcnt vmcnt(21)
    buffer_load_dwordx4 v48, s[20:23], s57 offen offset:0 nt lds
    s_waitcnt vmcnt(21)
    s_mov_b64 exec, 1
    v_mov_b32 v8, 29
    ds_write_b32 v4, v8 offset:18368
    s_mov_b64 exec, -1
    buffer_load_dwordx4 v49, s[20:23], s57 offen offset:1024 nt lds
    s_waitcnt vmcnt(21)
    buffer_load_dwordx4 v50, s[20:23], s57 offen offset:2048 nt lds
    s_waitcnt vmcnt(21)
    buffer_load_dwordx4 v51, s[20:23], s57 offen offset:3072 nt lds
    s_add_u32 s57, s50, 3
    s_and_b32 s57, s57, 7
    s_lshl_b32 s57, s57, 15
    s_mov_b32 m0, 12288
    s_add_u32 s57, s57, s47
    s_waitcnt vmcnt(21)
    buffer_load_dwordx4 v48, s[20:23], s57 offen offset:0 nt lds
    s_waitcnt vmcnt(21)
    s_mov_b64 exec, 1
    v_mov_b32 v8, 30
    ds_write_b32 v4, v8 offset:18368
    s_mov_b64 exec, -1
    buffer_load_dwordx4 v49, s[20:23], s57 offen offset:1024 nt lds
    s_waitcnt vmcnt(21)
    buffer_load_dwordx4 v50, s[20:23], s57 offen offset:2048 nt lds
    s_waitcnt vmcnt(21)
    buffer_load_dwordx4 v51, s[20:23], s57 offen offset:3072 nt lds
    s_add_u32 s57, s50, 4
    s_and_b32 s57, s57, 7
    s_lshl_b32 s57, s57, 15
    s_mov_b32 m0, 16384
    s_add_u32 s57, s57, s47
    s_waitcnt vmcnt(21)
    buffer_load_dwordx4 v48, s[20:23], s57 offen offset:0 nt lds
    s_waitcnt vmcnt(21)
    s_mov_b64 exec, 1
    v_mov_b32 v8, 31
    ds_write_b32 v4, v8 offset:18368
    s_mov_b64 exec, -1
    buffer_load_dwordx4 v49, s[20:23], s57 offen offset:1024 nt lds
    s_waitcnt vmcnt(21)
    buffer_load_dwordx4 v50, s[20:23], s57 offen offset:2048 nt lds
    s_waitcnt vmcnt(21)
    buffer_load_dwordx4 v51, s[20:23], s57 offen offset:3072 nt lds
    s_add_u32 s57, s50, 5
    s_and_b32 s57, s57, 7
    s_lshl_b32 s57, s57, 15
    s_mov_b32 m0, 20480
    s_add_u32 s57, s57, s47
    s_waitcnt vmcnt(21)
    buffer_load_dwordx4 v48, s[20:23], s57 offen offset:0 nt lds
    s_waitcnt vmcnt(21)
    s_mov_b64 exec, 1
    v_mov_b32 v8, 32
    ds_write_b32 v4, v8 offset:18368
    s_mov_b64 exec, -1
    buffer_load_dwordx4 v49, s[20:23], s57 offen offset:1024 nt lds
    s_waitcnt vmcnt(21)
    buffer_load_dwordx4 v50, s[20:23], s57 offen offset:2048 nt lds
    s_waitcnt vmcnt(21)
    buffer_load_dwordx4 v51, s[20:23], s57 offen offset:3072 nt lds
    s_add_u32 s57, s50, 6
    s_and_b32 s57, s57, 7
    s_lshl_b32 s57, s57, 15
    s_mov_b32 m0, 24576
    s_add_u32 s57, s57, s47
    s_waitcnt vmcnt(21)
    buffer_load_dwordx4 v48, s[20:23], s57 offen offset:0 nt lds
    s_waitcnt vmcnt(21)
    s_mov_b64 exec, 1
    v_mov_b32 v8, 33
    ds_write_b32 v4, v8 offset:18368
    s_mov_b64 exec, -1
    buffer_load_dwordx4 v49, s[20:23], s57 offen offset:1024 nt lds
    s_waitcnt vmcnt(21)
    buffer_load_dwordx4 v50, s[20:23], s57 offen offset:2048 nt lds
    s_waitcnt vmcnt(21)
    buffer_load_dwordx4 v51, s[20:23], s57 offen offset:3072 nt lds
    s_add_u32 s57, s50, 7
    s_and_b32 s57, s57, 7
    s_lshl_b32 s57, s57, 15
    s_mov_b32 m0, 28672
    s_add_u32 s57, s57, s47
    s_waitcnt vmcnt(21)
    buffer_load_dwordx4 v48, s[20:23], s57 offen offset:0 nt lds
    s_waitcnt vmcnt(21)
    s_mov_b64 exec, 1
    v_mov_b32 v8, 34
    ds_write_b32 v4, v8 offset:18368
    s_mov_b64 exec, -1
    buffer_load_dwordx4 v49, s[20:23], s57 offen offset:1024 nt lds
    s_waitcnt vmcnt(21)
    buffer_load_dwordx4 v50, s[20:23], s57 offen offset:2048 nt lds
    s_waitcnt vmcnt(21)
    buffer_load_dwordx4 v51, s[20:23], s57 offen offset:3072 nt lds
    s_mov_b32 s64, 0
L_w3:
    ds_read_b32 v7, v4 offset:18388
    s_add_u32 s64, s64, 1
    s_waitcnt lgkmcnt(0)
    v_readfirstlane_b32 s56, v7
    s_cmp_ge_u32 s56, 4
    s_cbranch_scc1 L_wd4
    s_cmp_lt_u32 s64, 1000000
    s_cbranch_scc1 L_w3
L_wd4:
    s_add_u32 s57, s50, 0
    s_and_b32 s57, s57, 7
    s_lshl_b32 s57, s57, 15
    s_mov_b32 m0, 98304
    s_add_u32 s57, s57, s65
    s_waitcnt vmcnt(20)
    s_mov_b64 exec, 1
    v_mov_b32 v8, 35
    ds_write_b32 v4, v8 offset:18368
    s_mov_b64 exec, -1
    s_waitcnt vmcnt(17)
    buffer_load_dwordx4 v48, s[28:31], s57 offen offset:0 nt lds
    s_waitcnt vmcnt(17)
    s_mov_b64 exec, 1
    v_mov_b32 v8, 36
    ds_write_b32 v4, v8 offset:18368
    s_mov_b64 exec, -1
    buffer_load_dwordx4 v49, s[28:31], s57 offen offset:1024 nt lds
    s_waitcnt vmcnt(17)
    buffer_load_dwordx4 v50, s[28:31], s57 offen offset:2048 nt lds
    s_waitcnt vmcnt(17)
    buffer_load_dwordx4 v51, s[28:31], s57 offen offset:3072 nt lds
    s_add_u32 s57, s50, 1
    s_and_b32 s57, s57, 7
    s_lshl_b32 s57, s57, 15
    s_mov_b32 m0, 102400
    s_add_u32 s57, s57, s65
    s_waitcnt vmcnt(17)
    buffer_load_dwordx4 v48, s[28:31], s57 offen offset:0 nt lds
    s_waitcnt vmcnt(17)
    s_mov_b64 exec, 1
    v_mov_b32 v8, 37
    ds_write_b32 v4, v8 offset:18368
    s_mov_b64 exec, -1
    buffer_load_dwordx4 v49, s[28:31], s57 offen offset:1024 nt lds
    s_waitcnt vmcnt(17)
    buffer_load_dwordx4 v50, s[28:31], s57 offen offset:2048 nt lds
    s_waitcnt vmcnt(17)
    buffer_load_dwordx4 v51, s[28:31], s57 offen offset:3072 nt lds
    s_add_u32 s57, s50, 2
    s_and_b32 s57, s57, 7
    s_lshl_b32 s57, s57, 15
    s_mov_b32 m0, 106496
    s_add_u32 s57, s57, s65
    s_waitcnt vmcnt(17)
    buffer_load_dwordx4 v48, s[28:31], s57 offen offset:0 nt lds
    s_waitcnt vmcnt(17)
    s_mov_b64 exec, 1
    v_mov_b32 v8, 38
    ds_write_b32 v4, v8 offset:18368
    s_mov_b64 exec, -1
    buffer_load_dwordx4 v49, s[28:31], s57 offen offset:1024 nt lds
    s_waitcnt vmcnt(17)
    buffer_load_dwordx4 v50, s[28:31], s57 offen offset:2048 nt lds
    s_waitcnt vmcnt(17)
    buffer_load_dwordx4 v51, s[28:31], s57 offen offset:3072 nt lds
    s_add_u32 s57, s50, 3
    s_and_b32 s57, s57, 7
    s_lshl_b32 s57, s57, 15
    s_mov_b32 m0, 110592
    s_add_u32 s57, s57, s65
    s_waitcnt vmcnt(17)
    buffer_load_dwordx4 v48, s[28:31], s57 offen offset:0 nt lds
    s_waitcnt vmcnt(17)
    s_mov_b64 exec, 1
    v_mov_b32 v8, 39
    ds_write_b32 v4, v8 offset:18368
    s_mov_b64 exec, -1
    buffer_load_dwordx4 v49, s[28:31], s57 offen offset:1024 nt lds
    s_waitcnt vmcnt(17)
    buffer_load_dwordx4 v50, s[28:31], s57 offen offset:2048 nt lds
    s_waitcnt vmcnt(17)
    buffer_load_dwordx4 v51, s[28:31], s57 offen offset:3072 nt lds
    s_add_u32 s57, s50, 4
    s_and_b32 s57, s57, 7
    s_lshl_b32 s57, s57, 15
    s_mov_b32 m0, 114688
    s_add_u32 s57, s57, s65
    s_waitcnt vmcnt(17)
    buffer_load_dwordx4 v48, s[28:31], s57 offen offset:0 nt lds
    s_waitcnt vmcnt(17)
    s_mov_b64 exec, 1
    v_mov_b32 v8, 40
    ds_write_b32 v4, v8 offset:18368
    s_mov_b64 exec, -1
    buffer_load_dwordx4 v49, s[28:31], s57 offen offset:1024 nt lds
    s_waitcnt vmcnt(17)
    buffer_load_dwordx4 v50, s[28:31], s57 offen offset:2048 nt lds
    s_waitcnt vmcnt(17)
    buffer_load_dwordx4 v51, s[28:31], s57 offen offset:3072 nt lds
    s_add_u32 s57, s50, 5
    s_and_b32 s57, s57, 7
    s_lshl_b32 s57, s57, 15
    s_mov_b32 m0, 118784
    s_add_u32 s57, s57, s65
    s_waitcnt vmcnt(17)
    buffer_load_dwordx4 v48, s[28:31], s57 offen offset:0 nt lds
    s_waitcnt vmcnt(17)
    s_mov_b64 exec, 1
    v_mov_b32 v8, 41
    ds_write_b32 v4, v8 offset:18368
    s_mov_b64 exec, -1
    buffer_load_dwordx4 v49, s[28:31], s57 offen offset:1024 nt lds
    s_waitcnt vmcnt(17)
    buffer_load_dwordx4 v50, s[28:31], s57 offen offset:2048 nt lds
    s_waitcnt vmcnt(17)
    buffer_load_dwordx4 v51, s[28:31], s57 offen offset:3072 nt lds
    s_add_u32 s57, s50, 6
    s_and_b32 s57, s57, 7
    s_lshl_b32 s57, s57, 15
    s_mov_b32 m0, 122880
    s_add_u32 s57, s57, s65
    s_waitcnt vmcnt(17)
    buffer_load_dwordx4 v48, s[28:31], s57 offen offset:0 nt lds
    s_waitcnt vmcnt(17)
    s_mov_b64 exec, 1
    v_mov_b32 v8, 42
    ds_write_b32 v4, v8 offset:18368
    s_mov_b64 exec, -1
    buffer_load_dwordx4 v49, s[28:31], s57 offen offset:1024 nt lds
    s_waitcnt vmcnt(17)
    buffer_load_dwordx4 v50, s[28:31], s57 offen offset:2048 nt lds
    s_waitcnt vmcnt(17)
    buffer_load_dwordx4 v51, s[28:31], s57 offen offset:3072 nt lds
    s_add_u32 s57, s50, 7
    s_and_b32 s57, s57, 7
    s_lshl_b32 s57, s57, 15
    s_mov_b32 m0, 126976
    s_add_u32 s57, s57, s65
    s_waitcnt vmcnt(17)
    buffer_load_dwordx4 v48, s[28:31], s57 offen offset:0 nt lds
    s_waitcnt vmcnt(17)
    s_mov_b64 exec, 1
    v_mov_b32 v8, 43
    ds_write_b32 v4, v8 offset:18368
    s_mov_b64 exec, -1
    buffer_load_dwordx4 v49, s[28:31], s57 offen offset:1024 nt lds
    s_waitcnt vmcnt(17)
    buffer_load_dwordx4 v50, s[28:31], s57 offen offset:2048 nt lds
    s_waitcnt vmcnt(17)
    buffer_load_dwordx4 v51, s[28:31], s57 offen offset:3072 nt lds
    s_waitcnt vmcnt(16)
    s_mov_b64 exec, 1
    v_mov_b32 v8, 44
    ds_write_b32 v4, v8 offset:18368
    s_mov_b64 exec, -1
    s_waitcnt vmcnt(12)
    s_mov_b64 exec, 1
    v_mov_b32 v8, 45
    ds_write_b32 v4, v8 offset:18368
    s_mov_b64 exec, -1
    s_waitcnt vmcnt(8)
    s_mov_b64 exec, 1
    v_mov_b32 v8, 46
    ds_write_b32 v4, v8 offset:18368
    s_mov_b64 exec, -1
    s_waitcnt vmcnt(4)
    s_mov_b64 exec, 1
    v_mov_b32 v8, 47
    ds_write_b32 v4, v8 offset:18368
    s_mov_b64 exec, -1
    s_waitcnt vmcnt(0)
    s_mov_b64 exec, 1
    v_mov_b32 v8, 48
    ds_write_b32 v4, v8 offset:18368
    s_mov_b64 exec, -1
    s_endpgm
L_notloader:
    v_lshlrev_b32 v1, 4, v16
    v_mov_b32 v5, 0xff
    v_mov_b32 v6, 1
    s_mov_b32 s62, 0x00ff00ff
    s_mov_b32 s63, 0x00ff00ff
    s_mov_b32 s66, 0xffff0000
    s_mul_i32 s50, s48, 1
    s_mul_i32 s56, s51, 2
    s_add_u32 s50, s50, s56
    s_and_b32 s50, s50, 7
    s_and_b32 s52, s49, 7
    s_lshl_b32 s53, s48, 2
    s_add_u32 s53, s53, s51
    s_mul_i32 s59, s60, 14
    s_add_u32 s59, s59, s61
    s_cmp_gt_u32 s61, 3
    s_subb_u32 s59, s59, 0
    s_cmp_gt_u32 s61, 11
    s_subb_u32 s59, s59, 0
    s_cmp_lg_u32 s52, 3
    s_cselect_b32 s67, 1, 0
    s_mul_i32 s69, s48, 3
    s_add_u32 s69, s69, s51
    s_lshr_b32 s56, s48, 1
    s_add_u32 s56, s56, 24
    s_xor_b32 s57, s48, s52
    s_and_b32 s57, s57, 1
    s_cmp_eq_u32 s51, 3
    s_cselect_b32 s69, s56, s69
    s_cselect_b32 s68, s57, 1
    s_mov_b32 s40, s82
    s_mov_b32 s41, s83
    s_mov_b32 s42, 268435456
    s_mov_b32 s43, 0x20000
    v_lshlrev_b32 v9, 4, v3
    v_lshl_add_u32 v9, v2, 2, v9
    v_lshrrev_b32 v17, 2, v16
    v_and_b32 v18, 7, v17
    v_lshlrev_b32 v18, 5, v18
    v_and_b32 v19, 3, v16
    v_lshl_add_u32 v18, v19, 3, v18
    v_lshl_add_u32 v10, v17, 8, v18
    v_and_b32 v20, 7, v3
    v_mul_u32_u24 v11, 288, v20
    v_add_u32 v11, 131072, v11
    v_lshl_add_u32 v11, v2, 3, v11
    v_lshl_add_u32 v8, v20, 2, v4
    s_cmp_ge_u32 s3, 5
    s_cbranch_scc1 L_A
    s_sub_u32 s55, s3, 1
    s_mov_b32 s36, s78
    s_mov_b32 s37, s79
    s_mov_b32 s38, 16384
    s_mov_b32 s39, 0x20000
    v_lshrrev_b32 v21, 3, v16
    v_and_b32 v18, 3, v21
    v_xor_b32 v18, s55, v18
    v_lshlrev_b32 v18, 5, v18
    v_lshl_add_u32 v18, v19, 3, v18
    v_lshl_add_u32 v12, v17, 7, v18
    v_add_u32 v13, 98304, v12
    v_mul_u32_u24 v23, 144, v20
    v_lshl_add_u32 v23, v2, 3, v23
    s_lshl_b32 s56, s55, 5
    s_add_u32 s56, s56, 131072
    v_add_u32 v23, s56, v23
    v_mul_u32_u24 v24, 144, v21
    v_lshl_add_u32 v24, v20, 4, v24
    v_add_u32 v24, 131072, v24
    v_lshlrev_b32 v25, 15, v21
    v_lshl_add_u32 v25, v20, 4, v25
    v_lshlrev_b32 v26, 12, v3
    v_lshrrev_b32 v18, 1, v2
    v_xor_b32 v18, v18, v20
    v_lshlrev_b32 v18, 4, v18
    v_lshl_add_u32 v18, v20, 9, v18
    v_and_b32 v21, 1, v2
    v_lshl_add_u32 v18, v21, 3, v18
    v_add_u32 v22, 131072, v18
    s_lshl_b32 s58, s60, 4
    s_add_u32 s58, s58, s61
    s_lshr_b32 s56, s58, 1
    s_lshl_b32 s56, s56, 10
    s_and_b32 s57, s58, 1
    s_lshl_b32 s84, s57, 7
    s_add_u32 s84, s84, s56
    s_lshl_b32 s86, s57, 5
    s_lshl_b32 s56, s56, 5
    s_add_u32 s86, s86, s56
    s_lshl_b32 s56, s54, 8
    s_add_u32 s84, s84, s56
    s_add_u32 s84, s84, 262144
    s_lshl_b32 s56, s54, 3
    s_add_u32 s86, s86, s56
    s_add_u32 s86, s86, 3146752
    s_lshr_b32 s56, s59, 1
    s_lshl_b32 s56, s56, 10
    s_and_b32 s57, s59, 1
    s_lshl_b32 s85, s57, 7
    s_add_u32 s85, s85, s56
    s_lshl_b32 s87, s57, 5
    s_lshl_b32 s56, s56, 5
    s_add_u32 s87, s87, s56
    s_lshl_b32 s56, s54, 8
    s_add_u32 s85, s85, s56
    s_add_u32 s85, s85, 524288
    s_lshl_b32 s56, s54, 3
    s_add_u32 s87, s87, s56
    s_add_u32 s87, s87, 3147776
    s_and_b32 s56, s86, 63
    s_lshr_b32 s56, s56, 1
    s_sub_u32 s96, s86, s56
    s_and_b32 s56, s87, 63
    s_lshr_b32 s56, s56, 1
    s_sub_u32 s97, s87, s56
    s_waitcnt lgkmcnt(0)
    s_and_b32 s56, s44, 0x7f7f7f7f
    s_add_u32 s56, s56, 0x01010101
    s_and_b32 s57, s44, 0x80808080
    s_xor_b32 s44, s56, s57
    s_lshr_b32 s45, s44, 8
    s_lshr_b32 s46, s44, 16
    s_lshr_b32 s47, s44, 24
    v_mov_b32 v14, s44
    s_mov_b32 s64, 0
L_w5:
    ds_read_b32 v7, v4 offset:18384
    s_add_u32 s64, s64, 1
    s_waitcnt lgkmcnt(0)
    v_readfirstlane_b32 s56, v7
    s_cmp_ge_u32 s56, 1
    s_cbranch_scc1 L_wd6
    s_sleep 2
    s_cmp_lt_u32 s64, 1000000
    s_cbranch_scc1 L_w5
L_wd6:
    v_xor_b32 v7, 0, v22
    ds_read_b64 v[32:33], v7
    v_xor_b32 v7, 32, v22
    ds_read_b64 v[34:35], v7
    v_xor_b32 v7, 64, v22
    ds_read_b64 v[36:37], v7
    v_xor_b32 v7, 96, v22
    ds_read_b64 v[38:39], v7
    v_xor_b32 v7, 128, v22
    ds_read_b64 v[40:41], v7
    v_xor_b32 v7, 160, v22
    ds_read_b64 v[42:43], v7
    v_xor_b32 v7, 192, v22
    ds_read_b64 v[44:45], v7
    v_xor_b32 v7, 224, v22
    ds_read_b64 v[46:47], v7
    v_xor_b32 v7, 256, v22
    ds_read_b64 v[48:49], v7
    v_xor_b32 v7, 288, v22
    ds_read_b64 v[50:51], v7
    v_xor_b32 v7, 320, v22
    ds_read_b64 v[52:53], v7
    v_xor_b32 v7, 352, v22
    ds_read_b64 v[54:55], v7
    v_xor_b32 v7, 384, v22
    ds_read_b64 v[56:57], v7
    v_xor_b32 v7, 416, v22
    ds_read_b64 v[58:59], v7
    v_xor_b32 v7, 448, v22
    ds_read_b64 v[60:61], v7
    v_xor_b32 v7, 480, v22
    ds_read_b64 v[62:63], v7
    s_mov_b32 s64, 0
L_w7:
    ds_read_b32 v7, v4 offset:18368
    s_add_u32 s64, s64, 1
    s_waitcnt lgkmcnt(0)
    v_readfirstlane_b32 s56, v7
    s_cmp_ge_u32 s56, 5
    s_cbranch_scc1 L_wd8
    s_sleep 4
    s_cmp_lt_u32 s64, 1000000
    s_cbranch_scc1 L_w7
L_wd8:
    ds_read_b64_tr_b16 v[64:65], v12 offset:0
    ds_read_b64_tr_b16 v[66:67], v12 offset:2048
    ds_read_b64_tr_b16 v[68:69], v12 offset:4096
    ds_read_b64_tr_b16 v[70:71], v12 offset:6144
    ds_read_b64_tr_b16 v[72:73], v12 offset:8192
    ds_read_b64_tr_b16 v[74:75], v12 offset:10240
    ds_read_b64_tr_b16 v[76:77], v12 offset:12288
    ds_read_b64_tr_b16 v[78:79], v12 offset:14336
    ds_read_b64_tr_b16 v[80:81], v12 offset:16384
    ds_read_b64_tr_b16 v[82:83], v12 offset:18432
    s_waitcnt lgkmcnt(8)
    v_mfma_f32_16x16x32_bf16 v[96:99], v[64:67], v[32:35], 0
    s_waitcnt lgkmcnt(6)
    v_mfma_f32_16x16x32_bf16 v[96:99], v[68:71], v[36:39], v[96:99]
    s_waitcnt lgkmcnt(4)
    v_mfma_f32_16x16x32_bf16 v[96:99], v[72:75], v[40:43], v[96:99]
    s_waitcnt lgkmcnt(2)
    v_mfma_f32_16x16x32_bf16 v[96:99], v[76:79], v[44:47], v[96:99]
    s_waitcnt lgkmcnt(0)
    v_mfma_f32_16x16x32_bf16 v[96:99], v[80:83], v[48:51], v[96:99]
    s_mov_b32 s64, 0
L_w9:
    ds_read_b32 v7, v4 offset:18368
    s_add_u32 s64, s64, 1
    s_waitcnt lgkmcnt(0)
    v_readfirstlane_b32 s56, v7
    s_cmp_ge_u32 s56, 7
    s_cbranch_scc1 L_wd10
    s_cmp_lt_u32 s64, 1000000
    s_cbranch_scc1 L_w9
L_wd10:
    ds_read_b64_tr_b16 v[84:85], v12 offset:20480
    ds_read_b64_tr_b16 v[86:87], v12 offset:22528
    ds_read_b64_tr_b16 v[88:89], v12 offset:24576
    ds_read_b64_tr_b16 v[90:91], v12 offset:26624
    s_waitcnt lgkmcnt(2)
    v_mfma_f32_16x16x32_bf16 v[96:99], v[84:87], v[52:55], v[96:99]
    s_waitcnt lgkmcnt(0)
    v_mfma_f32_16x16x32_bf16 v[96:99], v[88:91], v[56:59], v[96:99]
    s_mov_b32 s64, 0
L_w11:
    ds_read_b32 v7, v4 offset:18368
    ds_read_b64_tr_b16 v[92:93], v12 offset:28672
    ds_read_b64_tr_b16 v[94:95], v12 offset:30720
    s_add_u32 s64, s64, 1
    s_waitcnt lgkmcnt(2)
    v_readfirstlane_b32 s56, v7
    s_cmp_ge_u32 s56, 8
    s_cbranch_scc1 L_wd12
    s_cmp_lt_u32 s64, 1000000
    s_cbranch_scc1 L_w11
L_wd12:
    s_waitcnt lgkmcnt(0)
    v_mfma_f32_16x16x32_bf16 v[96:99], v[92:95], v[60:63], v[96:99]
    s_nop 6
    s_mov_b64 exec, s[62:63]
    v_cvt_pk_bf16_f32 v96, v96, v97
    v_cvt_pk_bf16_f32 v97, v98, v99
    ds_write_b64 v23, v[96:97] offset:13312
    v_add_u32 v98, v96, v97
    ds_add_u32 v8, v98 offset:18400
    s_mov_b64 exec, 1
    ds_add_rtn_u32 v7, v4, v6 offset:18376
    s_mov_b64 exec, -1
    ds_read_b128 v[104:107], v24 offset:13312
    ds_read_b32 v15, v8 offset:18400
    s_waitcnt lgkmcnt(2)
    v_readfirstlane_b32 s56, v7
    s_cmp_lg_u32 s56, 3
    s_cbranch_scc1 L_pb13
    s_waitcnt lgkmcnt(0)
    buffer_store_dwordx4 v[104:107], v25, s[40:43], s84 offen sc1
    s_mov_b64 exec, 0xff
    buffer_store_dwordx2 v[14:15], v26, s[40:43], s86 offen sc1
    s_mov_b64 exec, -1
L_pb13:
    s_lshl_b32 s90, s55, 16
    s_lshl_b32 s56, s69, 10
    s_add_u32 s90, s90, s56
    s_add_u32 s90, s90, 524288
    s_add_u32 s91, s90, 32768
    s_lshl_b32 s88, s55, 8
    s_add_u32 s88, s88, s56
    s_lshl_b32 s88, s88, 5
    s_add_u32 s88, s88, 3147776
    s_add_u32 s89, s88, 4096
    s_cmp_lg_u32 s55, 1
    s_cbranch_scc1 L_ngf
    s_lshr_b32 s58, s2, 2
    s_lshl_b32 s58, s58, 12
    s_add_u32 s58, s58, 3148800
    s_mov_b32 s64, 0
L_w14:
    ds_read_b32 v7, v4 offset:18368
    s_add_u32 s64, s64, 1
    s_waitcnt lgkmcnt(0)
    v_readfirstlane_b32 s56, v7
    s_cmp_ge_u32 s56, 12
    s_cbranch_scc1 L_wd15
    s_sleep 2
    s_cmp_lt_u32 s64, 1000000
    s_cbranch_scc1 L_w14
L_wd15:
    s_mov_b32 s64, 0
L_p16:
    s_load_dwordx16 s[4:19], s[40:41], s58 glc
    s_add_u32 s64, s64, 1
    s_cmp_ge_u32 s64, 100000
    s_waitcnt lgkmcnt(0)
    s_cbranch_scc1 L_pd17
    s_xor_b32 s56, s5, s44
    s_xor_b32 s57, s7, s44
    s_or_b32 s56, s56, s57
    s_xor_b32 s57, s9, s44
    s_or_b32 s56, s56, s57
    s_xor_b32 s57, s11, s44
    s_or_b32 s56, s56, s57
    s_xor_b32 s57, s13, s44
    s_or_b32 s56, s56, s57
    s_xor_b32 s57, s15, s44
    s_or_b32 s56, s56, s57
    s_xor_b32 s57, s17, s44
    s_or_b32 s56, s56, s57
    s_xor_b32 s57, s19, s44
    s_or_b32 s56, s56, s57
    s_cbranch_scc0 L_pd17
    s_cmp_gt_u32 s64, 99
    s_cbranch_scc1 L_p16
    s_sleep 3
    s_branch L_p16
L_pd17:
    v_writelane_b32 v7, s4, 0
    v_writelane_b32 v7, s6, 1
    v_writelane_b32 v7, s8, 2
    v_writelane_b32 v7, s10, 3
    v_writelane_b32 v7, s12, 4
    v_writelane_b32 v7, s14, 5
    v_writelane_b32 v7, s16, 6
    v_writelane_b32 v7, s18, 7
    s_mov_b64 exec, 0xff
    ds_write_b32 v8, v7 offset:18336
    s_mov_b64 exec, 1
    ds_add_u32 v4, v6 offset:18496
    s_mov_b64 exec, -1
L_ngf:
    s_mul_i32 s57, s55, 576
    s_add_u32 s57, s57, 137472
    s_lshl_b32 s56, s50, 5
    v_subrev_u32 v27, s56, v9
    v_and_b32 v17, 0xc4, v27
    v_bfe_u32 v18, v27, 3, 2
    v_lshl_add_u32 v17, v18, 4, v17
    v_bfe_u32 v18, v27, 5, 1
    v_lshl_add_u32 v17, v18, 3, v17
    v_add_u32 v27, s57, v17
    v_lshl_add_u32 v22, v2, 3, v11
    s_lshl_b32 s56, s55, 6
    v_xor_b32 v28, s56, v10
    v_add_u32 v28, 98304, v28
    v_xor_b32 v29, 32, v28
    s_lshl_b32 s57, s55, 7
    v_and_b32 v17, 7, v3
    v_mul_u32_u24 v30, 528, v17
    v_lshl_add_u32 v30, v2, 4, v30
    s_add_u32 s56, s57, 131072
    v_add_u32 v30, s56, v30
    v_lshrrev_b32 v18, 7, v1
    v_mul_u32_u24 v120, 528, v18
    v_lshl_add_u32 v120, v17, 4, v120
    s_lshl_b32 s56, s55, 7
    s_add_u32 s56, s56, 131072
    v_add_u32 v120, s56, v120
    v_lshlrev_b32 v121, 14, v18
    v_lshl_add_u32 v121, v17, 4, v121
    s_lshl_b32 s94, s52, 17
    s_lshl_b32 s56, s55, 12
    s_add_u32 s94, s94, s56
    s_lshl_b32 s56, s53, 7
    s_add_u32 s94, s94, s56
    s_add_u32 s94, s94, 2097152
    s_lshl_b32 s95, s55, 3
    s_lshl_b32 s92, s2, 12
    s_add_u32 s92, s92, 2097152
    s_lshr_b32 s93, s2, 5
    s_lshl_b32 s93, s93, 8
    s_lshr_b32 s57, s2, 2
    s_and_b32 s57, s57, 7
    s_lshl_b32 s57, s57, 11
    s_add_u32 s93, s93, s57
    s_and_b32 s57, s2, 3
    s_lshl_b32 s57, s57, 6
    s_add_u32 s93, s93, s57
    v_and_b32 v31, 7, v3
    v_lshlrev_b32 v31, 3, v31
    v_lshl_add_u32 v31, v2, 1, v31
    s_mov_b32 s64, 0
L_w18:
    ds_read_b32 v7, v4 offset:18368
    s_add_u32 s64, s64, 1
    s_waitcnt lgkmcnt(0)
    v_readfirstlane_b32 s56, v7
    s_cmp_ge_u32 s56, 22
    s_cbranch_scc1 L_wd19
    s_sleep 2
    s_cmp_lt_u32 s64, 1000000
    s_cbranch_scc1 L_w18
L_wd19:
    s_lshl_b32 s56, s55, 10
    s_add_u32 s56, s56, s92
    buffer_load_dwordx4 v[122:125], v1, s[40:43], s56 offen sc1
    s_mov_b32 s64, 0
L_w20:
    ds_read_b32 v7, v4 offset:18368
    s_add_u32 s64, s64, 1
    s_waitcnt lgkmcnt(0)
    v_readfirstlane_b32 s56, v7
    s_cmp_ge_u32 s56, 29
    s_cbranch_scc1 L_wd21
    s_sleep 4
    s_cmp_lt_u32 s64, 1000000
    s_cbranch_scc1 L_w20
L_wd21:
    ds_read_b64_tr_b16 v[64:65], v13 offset:0
    ds_read_b64_tr_b16 v[66:67], v13 offset:2048
    ds_read_b64_tr_b16 v[68:69], v13 offset:4096
    ds_read_b64_tr_b16 v[70:71], v13 offset:6144
    ds_read_b64_tr_b16 v[72:73], v13 offset:8192
    ds_read_b64_tr_b16 v[74:75], v13 offset:10240
    ds_read_b64_tr_b16 v[76:77], v13 offset:12288
    ds_read_b64_tr_b16 v[78:79], v13 offset:14336
    ds_read_b64_tr_b16 v[80:81], v13 offset:16384
    ds_read_b64_tr_b16 v[82:83], v13 offset:18432
    s_waitcnt lgkmcnt(8)
    v_mfma_f32_16x16x32_bf16 v[96:99], v[64:67], v[32:35], 0
    s_waitcnt lgkmcnt(6)
    v_mfma_f32_16x16x32_bf16 v[96:99], v[68:71], v[36:39], v[96:99]
    s_waitcnt lgkmcnt(4)
    v_mfma_f32_16x16x32_bf16 v[96:99], v[72:75], v[40:43], v[96:99]
    s_waitcnt lgkmcnt(2)
    v_mfma_f32_16x16x32_bf16 v[96:99], v[76:79], v[44:47], v[96:99]
    s_waitcnt lgkmcnt(0)
    v_mfma_f32_16x16x32_bf16 v[96:99], v[80:83], v[48:51], v[96:99]
    s_mov_b32 s64, 0
L_w22:
    ds_read_b32 v7, v4 offset:18368
    s_add_u32 s64, s64, 1
    s_waitcnt lgkmcnt(0)
    v_readfirstlane_b32 s56, v7
    s_cmp_ge_u32 s56, 31
    s_cbranch_scc1 L_wd23
    s_cmp_lt_u32 s64, 1000000
    s_cbranch_scc1 L_w22
L_wd23:
    ds_read_b64_tr_b16 v[84:85], v13 offset:20480
    ds_read_b64_tr_b16 v[86:87], v13 offset:22528
    ds_read_b64_tr_b16 v[88:89], v13 offset:24576
    ds_read_b64_tr_b16 v[90:91], v13 offset:26624
    s_waitcnt lgkmcnt(2)
    v_mfma_f32_16x16x32_bf16 v[96:99], v[84:87], v[52:55], v[96:99]
    s_waitcnt lgkmcnt(0)
    v_mfma_f32_16x16x32_bf16 v[96:99], v[88:91], v[56:59], v[96:99]
    s_mov_b32 s64, 0
L_w24:
    ds_read_b32 v7, v4 offset:18368
    ds_read_b64_tr_b16 v[92:93], v13 offset:28672
    ds_read_b64_tr_b16 v[94:95], v13 offset:30720
    s_add_u32 s64, s64, 1
    s_waitcnt lgkmcnt(2)
    v_readfirstlane_b32 s56, v7
    s_cmp_ge_u32 s56, 32
    s_cbranch_scc1 L_wd25
    s_cmp_lt_u32 s64, 1000000
    s_cbranch_scc1 L_w24
L_wd25:
    s_waitcnt lgkmcnt(0)
    v_mfma_f32_16x16x32_bf16 v[96:99], v[92:95], v[60:63], v[96:99]
    s_nop 6
    s_mov_b64 exec, s[62:63]
    v_cvt_pk_bf16_f32 v96, v96, v97
    v_cvt_pk_bf16_f32 v97, v98, v99
    ds_write_b64 v23, v[96:97] offset:14464
    v_add_u32 v98, v96, v97
    ds_add_u32 v8, v98 offset:18432
    s_mov_b64 exec, 1
    ds_add_rtn_u32 v7, v4, v6 offset:18388
    s_mov_b64 exec, -1
    ds_read_b128 v[104:107], v24 offset:14464
    ds_read_b32 v15, v8 offset:18432
    s_waitcnt lgkmcnt(2)
    v_readfirstlane_b32 s56, v7
    s_cmp_eq_u32 s67, 0
    s_cbranch_scc1 L_pb26
    s_cmp_lg_u32 s56, 3
    s_cbranch_scc1 L_pb26
    s_waitcnt lgkmcnt(0)
    buffer_store_dwordx4 v[104:107], v25, s[40:43], s85 offen sc1
    s_mov_b64 exec, 0xff
    buffer_store_dwordx2 v[14:15], v26, s[40:43], s87 offen sc1
    s_mov_b64 exec, -1
L_pb26:
    s_cmp_eq_u32 s68, 0
    s_cbranch_scc1 L_hdone
    s_mov_b32 s64, 0
L_p27:
    s_load_dwordx16 s[4:19], s[40:41], s88 glc
    s_load_dwordx16 s[20:35], s[40:41], s89 glc
    s_add_u32 s64, s64, 1
    s_cmp_ge_u32 s64, 100000
    s_waitcnt lgkmcnt(0)
    s_cbranch_scc1 L_pd28
    s_xor_b32 s56, s4, s44
    s_xor_b32 s57, s6, s44
    s_or_b32 s56, s56, s57
    s_xor_b32 s57, s8, s44
    s_or_b32 s56, s56, s57
    s_xor_b32 s57, s10, s44
    s_or_b32 s56, s56, s57
    s_xor_b32 s57, s12, s44
    s_or_b32 s56, s56, s57
    s_xor_b32 s57, s14, s44
    s_or_b32 s56, s56, s57
    s_xor_b32 s57, s16, s44
    s_or_b32 s56, s56, s57
    s_xor_b32 s57, s18, s44
    s_or_b32 s56, s56, s57
    s_xor_b32 s57, s20, s44
    s_or_b32 s56, s56, s57
    s_xor_b32 s57, s22, s44
    s_or_b32 s56, s56, s57
    s_xor_b32 s57, s24, s44
    s_or_b32 s56, s56, s57
    s_xor_b32 s57, s26, s44
    s_or_b32 s56, s56, s57
    s_xor_b32 s57, s28, s44
    s_or_b32 s56, s56, s57
    s_xor_b32 s57, s30, s44
    s_or_b32 s56, s56, s57
    s_xor_b32 s57, s32, s44
    s_or_b32 s56, s56, s57
    s_xor_b32 s57, s34, s44
    s_or_b32 s56, s56, s57
    s_cbranch_scc0 L_pd28
    s_cmp_gt_u32 s64, 99
    s_cbranch_scc1 L_p27
    s_sleep 3
    s_branch L_p27
L_pd28:
    buffer_load_dwordx4 v[104:107], v1, s[40:43], s90 offen sc1
    buffer_load_dwordx4 v[108:111], v1, s[40:43], s91 offen sc1
    s_add_u32 s65, s5, s7
    s_add_u32 s65, s65, s9
    s_add_u32 s65, s65, s11
    s_add_u32 s65, s65, s13
    s_add_u32 s65, s65, s15
    s_add_u32 s65, s65, s17
    s_add_u32 s65, s65, s19
    s_add_u32 s65, s65, s21
    s_add_u32 s65, s65, s23
    s_add_u32 s65, s65, s25
    s_add_u32 s65, s65, s27
    s_add_u32 s65, s65, s29
    s_add_u32 s65, s65, s31
    s_add_u32 s65, s65, s33
    s_add_u32 s65, s65, s35
    s_mov_b32 s64, 0
L_w32:
    ds_read_b32 v7, v4 offset:18496
    s_add_u32 s64, s64, 1
    s_waitcnt lgkmcnt(0)
    v_readfirstlane_b32 s56, v7
    s_cmp_ge_u32 s56, 1
    s_cbranch_scc1 L_wd33
    s_cmp_lt_u32 s64, 1000000
    s_cbranch_scc1 L_w32
L_wd33:
    s_lshl_b32 s56, s55, 3
    v_add_u32 v7, s56, v4
    ds_read_b64 v[20:21], v7 offset:18336
    s_waitcnt lgkmcnt(0)
    v_sub_f32 v20, 1.0, v20
    v_sub_f32 v21, 1.0, v21
    s_mov_b32 s64, 0
    s_branch L_ce31
L_c29:
    s_sleep 4
    buffer_load_dwordx4 v[104:107], v1, s[40:43], s90 offen sc1
    buffer_load_dwordx4 v[108:111], v1, s[40:43], s91 offen sc1
L_ce31:
    s_add_u32 s64, s64, 1
    s_waitcnt vmcnt(0)
    v_add3_u32 v7, v104, v105, v106
    v_add3_u32 v7, v107, v108, v7
    v_add3_u32 v7, v109, v110, v7
    v_add_u32 v7, v111, v7
    v_lshlrev_b32 v32, 16, v104
    v_and_b32 v33, s66, v104
    v_add_u32_dpp v7, v7, v7 row_ror:8 row_mask:0xf bank_mask:0xf
    v_lshlrev_b32 v34, 16, v105
    v_and_b32 v35, s66, v105
    v_add_u32_dpp v7, v7, v7 row_ror:4 row_mask:0xf bank_mask:0xf
    v_lshlrev_b32 v36, 16, v106
    v_and_b32 v37, s66, v106
    v_add_u32_dpp v7, v7, v7 row_ror:2 row_mask:0xf bank_mask:0xf
    v_lshlrev_b32 v38, 16, v107
    v_and_b32 v39, s66, v107
    v_add_u32_dpp v7, v7, v7 row_ror:1 row_mask:0xf bank_mask:0xf
    v_lshlrev_b32 v40, 16, v108
    v_and_b32 v41, s66, v108
    v_readlane_b32 s56, v7, 0
    v_readlane_b32 s57, v7, 16
    v_readlane_b32 s58, v7, 32
    v_readlane_b32 s49, v7, 48
    v_lshlrev_b32 v42, 16, v109
    v_and_b32 v43, s66, v109
    v_lshlrev_b32 v44, 16, v110
    v_and_b32 v45, s66, v110
    v_lshlrev_b32 v46, 16, v111
    v_and_b32 v47, s66, v111
    v_permlane32_swap_b32 v32, v36
    v_permlane32_swap_b32 v33, v37
    v_permlane32_swap_b32 v34, v38
    v_permlane32_swap_b32 v35, v39
    v_add_f32 v32, v32, v36
    v_add_f32 v34, v34, v38
    v_add_f32 v33, v33, v37
    v_add_f32 v35, v35, v39
    v_permlane32_swap_b32 v40, v44
    v_permlane32_swap_b32 v41, v45
    v_permlane32_swap_b32 v42, v46
    v_permlane32_swap_b32 v43, v47
    v_add_f32 v40, v40, v44
    v_add_f32 v42, v42, v46
    v_add_f32 v41, v41, v45
    v_add_f32 v43, v43, v47
    v_permlane16_swap_b32 v32, v34
    v_permlane16_swap_b32 v33, v35
    v_add_f32 v32, v32, v34
    v_add_f32 v33, v33, v35
    v_permlane16_swap_b32 v40, v42
    v_permlane16_swap_b32 v41, v43
    v_add_f32 v40, v40, v42
    v_add_f32 v41, v41, v43
    v_max_f32 v32, 0, v32
    v_max_f32 v33, 0, v33
    v_max_f32 v40, 0, v40
    v_max_f32 v41, 0, v41
    v_mul_f32 v32, v20, v32
    v_mul_f32 v33, v20, v33
    v_mul_f32 v40, v21, v40
    v_mul_f32 v41, v21, v41
    v_cvt_pk_bf16_f32 v32, v32, v33
    v_cvt_pk_bf16_f32 v40, v40, v41
    ds_write_b32 v27, v32
    ds_write_b32 v27, v40 offset:288
    s_add_u32 s56, s56, s57
    s_add_u32 s58, s58, s49
    s_add_u32 s56, s56, s58
    s_cmp_eq_u32 s56, s65
    s_cbranch_scc1 L_cd30
    s_cmp_lt_u32 s64, 100000
    s_cbranch_scc1 L_c29
L_cd30:
    s_mov_b64 exec, 1
    ds_add_u32 v4, v6 offset:18380
    s_mov_b64 exec, -1
    s_mov_b32 s59, 7
    s_mov_b32 s64, 0
L_bj:
    ds_read_b128 v[16:19], v4 offset:18368
    s_add_u32 s64, s64, 1
    s_waitcnt lgkmcnt(0)
    v_readfirstlane_b32 s56, v16
    v_readfirstlane_b32 s57, v19
    s_cmp_ge_u32 s64, 1000000
    s_cselect_b32 s56, 99, s56
    s_cselect_b32 s57, 99, s57
    s_cmp_ge_u32 s57, 4
    s_cselect_b32 s58, 2, 0
    s_cmp_ge_u32 s56, 46
    s_addc_u32 s58, s58, 0
    s_cmp_ge_u32 s56, 48
    s_cselect_b32 s57, 4, 0
    s_or_b32 s58, s58, s57
    s_and_b32 s58, s58, s59
    s_cbranch_scc0 L_bj
    s_andn2_b32 s59, s59, s58
    s_bitcmp1_b32 s58, 1
    s_cbranch_scc0 L_bj1
    ds_read_b128 v[48:51], v22 offset:6400
    ds_read_b128 v[52:55], v22 offset:6464
    ds_read_b128 v[56:59], v22 offset:6528
    ds_read_b128 v[60:63], v22 offset:6592
L_bj1:
    s_bitcmp1_b32 s58, 0
    s_cbranch_scc0 L_bj2
    ds_read_b64_tr_b16 v[64:65], v28 offset:0
    ds_read_b64_tr_b16 v[80:81], v29 offset:0
    ds_read_b64_tr_b16 v[66:67], v28 offset:4096
    ds_read_b64_tr_b16 v[82:83], v29 offset:4096
    ds_read_b64_tr_b16 v[68:69], v28 offset:8192
    ds_read_b64_tr_b16 v[84:85], v29 offset:8192
    ds_read_b64_tr_b16 v[70:71], v28 offset:12288
    ds_read_b64_tr_b16 v[86:87], v29 offset:12288
    ds_read_b64_tr_b16 v[72:73], v28 offset:16384
    ds_read_b64_tr_b16 v[88:89], v29 offset:16384
    ds_read_b64_tr_b16 v[74:75], v28 offset:20480
    ds_read_b64_tr_b16 v[90:91], v29 offset:20480
L_bj2:
    s_bitcmp1_b32 s58, 2
    s_cbranch_scc0 L_bj3
    ds_read_b64_tr_b16 v[76:77], v28 offset:24576
    ds_read_b64_tr_b16 v[92:93], v29 offset:24576
    ds_read_b64_tr_b16 v[78:79], v28 offset:28672
    ds_read_b64_tr_b16 v[94:95], v29 offset:28672
L_bj3:
    s_cmp_eq_u32 s59, 0
    s_cbranch_scc1 L_ball
    s_cmp_lg_u32 s59, 4
    s_cbranch_scc1 L_bj
    s_waitcnt lgkmcnt(0)
    v_mfma_f32_16x16x32_bf16 v[96:99], v[64:67], v[48:51], 0
    v_mfma_f32_16x16x32_bf16 v[100:103], v[80:83], v[48:51], 0
    v_mfma_f32_16x16x32_bf16 v[96:99], v[68:71], v[52:55], v[96:99]
    v_mfma_f32_16x16x32_bf16 v[100:103], v[84:87], v[52:55], v[100:103]
    v_mfma_f32_16x16x32_bf16 v[96:99], v[72:75], v[56:59], v[96:99]
    v_mfma_f32_16x16x32_bf16 v[100:103], v[88:91], v[56:59], v[100:103]
    s_mov_b32 s64, 0
L_w34:
    ds_read_b32 v7, v4 offset:18368
    ds_read_b64_tr_b16 v[76:77], v28 offset:24576
    ds_read_b64_tr_b16 v[92:93], v29 offset:24576
    ds_read_b64_tr_b16 v[78:79], v28 offset:28672
    ds_read_b64_tr_b16 v[94:95], v29 offset:28672
    s_add_u32 s64, s64, 1
    s_waitcnt lgkmcnt(4)
    v_readfirstlane_b32 s56, v7
    s_cmp_ge_u32 s56, 48
    s_cbranch_scc1 L_wd35
    s_cmp_lt_u32 s64, 1000000
    s_cbranch_scc1 L_w34
L_wd35:
    s_waitcnt lgkmcnt(0)
    s_branch L_blast
L_ball:
    s_waitcnt lgkmcnt(0)
    v_mfma_f32_16x16x32_bf16 v[96:99], v[64:67], v[48:51], 0
    v_mfma_f32_16x16x32_bf16 v[100:103], v[80:83], v[48:51], 0
    v_mfma_f32_16x16x32_bf16 v[96:99], v[68:71], v[52:55], v[96:99]
    v_mfma_f32_16x16x32_bf16 v[100:103], v[84:87], v[52:55], v[100:103]
    v_mfma_f32_16x16x32_bf16 v[96:99], v[72:75], v[56:59], v[96:99]
    v_mfma_f32_16x16x32_bf16 v[100:103], v[88:91], v[56:59], v[100:103]
L_blast:
    v_mfma_f32_16x16x32_bf16 v[96:99], v[76:79], v[60:63], v[96:99]
    v_mfma_f32_16x16x32_bf16 v[100:103], v[92:95], v[60:63], v[100:103]
    s_nop 5
    s_mov_b64 exec, s[62:63]
    ds_write_b128 v30, v[96:99] offset:22736
    ds_write_b128 v30, v[100:103] offset:22800
    s_mov_b64 exec, 1
    v_lshlrev_b32 v7, s95, v6
    ds_add_rtn_u32 v7, v4, v7 offset:18396
    s_mov_b64 exec, -1
    ds_read_b128 v[32:35], v120 offset:18512
    ds_read_b128 v[36:39], v120 offset:22736
    s_add_u32 s57, s68, 1
    s_waitcnt lgkmcnt(2)
    v_readfirstlane_b32 s56, v7
    s_lshr_b32 s56, s56, s95
    s_and_b32 s56, s56, 0xff
    s_cmp_lg_u32 s56, s57
    s_cbranch_scc1 L_hdone
    s_cmp_eq_u32 s68, 0
    s_waitcnt lgkmcnt(0)
    s_cbranch_scc1 L_rz36
    v_add_f32 v32, v32, v36
    v_add_f32 v33, v33, v37
    v_add_f32 v34, v34, v38
    v_add_f32 v35, v35, v39
L_rz36:
    v_bfi_b32 v32, v5, s44, v32
    v_bfi_b32 v33, v5, s45, v33
    v_bfi_b32 v34, v5, s46, v34
    v_bfi_b32 v35, v5, s47, v35
    buffer_store_dwordx4 v[32:35], v121, s[40:43], s94 offen sc1
    s_mov_b64 exec, 1
    v_mov_b32 v7, 2
    ds_add_u32 v4, v7 offset:18372
    s_mov_b64 exec, -1
L_hdone:
    s_cmp_lg_u32 s55, 0
    s_cbranch_scc1 L_end
    s_mov_b32 s64, 0
L_w37:
    ds_read_b32 v7, v4 offset:18372
    s_add_u32 s64, s64, 1
    s_waitcnt lgkmcnt(0)
    v_readfirstlane_b32 s56, v7
    s_cmp_ge_u32 s56, 32
    s_cbranch_scc1 L_wd38
    s_sleep 4
    s_cmp_lt_u32 s64, 1000000
    s_cbranch_scc1 L_w37
L_wd38:
    s_mov_b32 s64, 0
L_c39:
    buffer_load_dwordx4 v[104:107], v1, s[40:43], s92 offen offset:0 sc1
    buffer_load_dwordx4 v[108:111], v1, s[40:43], s92 offen offset:1024 sc1
    buffer_load_dwordx4 v[112:115], v1, s[40:43], s92 offen offset:2048 sc1
    buffer_load_dwordx4 v[116:119], v1, s[40:43], s92 offen offset:3072 sc1
    s_add_u32 s64, s64, 1
    s_waitcnt vmcnt(3)
    v_xor_b32 v7, s44, v104
    v_bitop3_b32 v7, v105, s45, v7 bitop3:0xbe
    v_bitop3_b32 v7, v106, s46, v7 bitop3:0xbe
    v_bitop3_b32 v7, v107, s47, v7 bitop3:0xbe
    v_and_b32 v104, 0xffffff00, v104
    v_and_b32 v105, 0xffffff00, v105
    v_and_b32 v106, 0xffffff00, v106
    v_and_b32 v107, 0xffffff00, v107
    s_waitcnt vmcnt(2)
    v_bitop3_b32 v7, v108, s44, v7 bitop3:0xbe
    v_bitop3_b32 v7, v109, s45, v7 bitop3:0xbe
    v_bitop3_b32 v7, v110, s46, v7 bitop3:0xbe
    v_bitop3_b32 v7, v111, s47, v7 bitop3:0xbe
    v_and_b32 v108, 0xffffff00, v108
    v_and_b32 v109, 0xffffff00, v109
    v_and_b32 v110, 0xffffff00, v110
    v_and_b32 v111, 0xffffff00, v111
    v_add_f32 v104, v104, v108
    v_add_f32 v105, v105, v109
    v_add_f32 v106, v106, v110
    v_add_f32 v107, v107, v111
    s_waitcnt vmcnt(1)
    v_bitop3_b32 v7, v112, s44, v7 bitop3:0xbe
    v_bitop3_b32 v7, v113, s45, v7 bitop3:0xbe
    v_bitop3_b32 v7, v114, s46, v7 bitop3:0xbe
    v_bitop3_b32 v7, v115, s47, v7 bitop3:0xbe
    v_and_b32 v112, 0xffffff00, v112
    v_and_b32 v113, 0xffffff00, v113
    v_and_b32 v114, 0xffffff00, v114
    v_and_b32 v115, 0xffffff00, v115
    v_add_f32 v104, v104, v112
    v_add_f32 v105, v105, v113
    v_add_f32 v106, v106, v114
    v_add_f32 v107, v107, v115
    s_waitcnt vmcnt(0)
    v_bitop3_b32 v7, v116, s44, v7 bitop3:0xbe
    v_bitop3_b32 v7, v117, s45, v7 bitop3:0xbe
    v_bitop3_b32 v7, v118, s46, v7 bitop3:0xbe
    v_bitop3_b32 v7, v119, s47, v7 bitop3:0xbe
    v_and_b32 v7, 0xff, v7
    v_cmp_ne_u32 vcc, 0, v7
    v_and_b32 v116, 0xffffff00, v116
    v_and_b32 v117, 0xffffff00, v117
    v_and_b32 v118, 0xffffff00, v118
    v_and_b32 v119, 0xffffff00, v119
    v_add_f32 v104, v104, v116
    v_add_f32 v105, v105, v117
    v_add_f32 v106, v106, v118
    v_add_f32 v107, v107, v119
    s_cmp_ge_u32 s64, 100000
    s_cbranch_scc1 L_cd40
    s_cbranch_vccnz L_c39
L_cd40:
    v_permlane32_swap_b32 v104, v106
    v_permlane32_swap_b32 v105, v107
    v_add_f32 v104, v104, v106
    v_add_f32 v105, v105, v107
    s_nop 1
    v_permlane16_swap_b32 v104, v105
    v_add_f32 v104, v104, v105
    s_cmp_lg_u32 s2, 0
    s_nop 0
    v_add_f32_dpp v104, v104, v104 row_ror:8 row_mask:0xf bank_mask:0xf
    v_cvt_pk_bf16_f32 v104, v104, v104
    s_mov_b64 exec, s[62:63]
    buffer_store_short v104, v31, s[36:39], s93 offen
    s_cbranch_scc1 L_end
    s_mov_b64 exec, 1
    v_mov_b32 v17, 0
    buffer_store_dword v14, v17, s[40:43], 0 offen
    s_endpgm
L_A:
    s_sub_u32 s55, s3, 5
    s_or_b32 s58, s55, s49
    s_cbranch_scc1 L_nogl
    s_mov_b32 s6, 16384
    s_mov_b32 s7, 0x20000
    s_mov_b32 s32, s76
    s_mov_b32 s33, s77
    s_mov_b32 s34, 2048
    s_mov_b32 s35, 0x20000
    s_lshl_b32 s56, s48, 11
    buffer_load_dwordx4 v[32:35], v1, s[4:7], s56 offen
    buffer_load_dwordx4 v[36:39], v1, s[4:7], s56 offen offset:1024
    buffer_load_dwordx4 v[40:43], v1, s[32:35], 0 offen
    buffer_load_dwordx4 v[44:47], v1, s[32:35], 0 offen offset:1024
L_nogl:
    s_mov_b32 s69, s58
    s_cmp_lg_u32 s55, 3
    s_cbranch_scc1 L_nz
    v_mov_b32 v28, 0
    v_mov_b32 v29, 0
    v_mov_b32 v30, 0
    v_mov_b32 v31, 0
    s_mov_b64 exec, 1
    ds_write_b128 v4, v[28:31] offset:17792
    ds_write_b128 v4, v[28:31] offset:17808
    s_mov_b64 exec, -1
L_nz:
    v_xor_b32 v112, v2, v3
    v_lshlrev_b32 v112, 4, v112
    v_lshl_add_u32 v112, v3, 8, v112
    s_lshl_b32 s56, s55, 12
    s_add_u32 s56, s56, 32768
    v_add_u32 v112, s56, v112
    v_xor_b32 v113, 64, v112
    v_xor_b32 v114, 128, v112
    v_xor_b32 v115, 192, v112
    s_lshl_b32 s56, s55, 5
    v_xor_b32 v12, s56, v10
    v_add_u32 v13, 65536, v12
    v_add_u32 v124, s56, v11
    v_mul_u32_u24 v125, 288, v2
    v_lshl_add_u32 v125, v3, 4, v125
    v_add_u32 v125, 131072, v125
    s_mul_i32 s58, s55, 288
    s_add_u32 s58, s58, 131072
    v_add_u32 v116, s58, v9
    s_lshl_b32 s56, s50, 5
    v_subrev_u32 v24, s56, v9
    v_and_b32 v17, 0xc4, v24
    v_bfe_u32 v18, v24, 3, 2
    v_lshl_add_u32 v17, v18, 4, v17
    v_bfe_u32 v18, v24, 5, 1
    v_lshl_add_u32 v17, v18, 3, v17
    v_add_u32 v24, s58, v17
    v_lshl_add_u32 v117, v2, 3, v11
    v_lshl_add_u32 v17, v20, 5, v4
    v_mul_u32_u24 v18, 272, v20
    v_lshl_add_u32 v18, v2, 6, v18
    v_add_u32 v18, 131072, v18
    s_lshl_b32 s56, s55, 3
    v_add_u32 v118, s56, v18
    s_lshl_b32 s56, s55, 2
    v_add_u32 v119, s56, v17
    v_add_u32 v25, s56, v4
    v_add_u32 v120, 15616, v18
    v_add_u32 v121, 15648, v18
    v_mov_b32 v7, 148864
    v_cndmask_b32 v120, v7, v120, s[62:63]
    v_cndmask_b32 v121, v121, v7, s[62:63]
    v_lshrrev_b32 v21, 3, v3
    v_lshl_add_u32 v122, v21, 4, v17
    v_xor_b32 v123, 16, v122
    v_lshlrev_b32 v126, 14, v2
    v_lshl_add_u32 v126, v3, 4, v126
    v_lshlrev_b32 v127, 15, v3
    s_lshl_b32 s57, s55, 6
    s_lshr_b32 s58, s55, 1
    v_and_b32 v17, 7, v3
    v_mul_u32_u24 v15, 528, v17
    v_lshl_add_u32 v15, v2, 4, v15
    s_add_u32 s56, s57, 131072
    v_add_u32 v15, s56, v15
    v_lshrrev_b32 v18, 7, v1
    v_mul_u32_u24 v27, 528, v18
    v_lshl_add_u32 v27, v17, 4, v27
    s_lshl_b32 s56, s58, 7
    s_add_u32 s56, s56, 131072
    v_add_u32 v27, s56, v27
    v_lshlrev_b32 v26, 14, v18
    v_lshl_add_u32 v26, v17, 4, v26
    s_lshl_b32 s92, s52, 17
    s_lshl_b32 s56, s58, 12
    s_add_u32 s92, s92, s56
    s_lshl_b32 s56, s53, 7
    s_add_u32 s92, s92, s56
    s_add_u32 s92, s92, 2097152
    s_lshl_b32 s93, s58, 3
    s_lshl_b32 s58, s51, 3
    s_add_u32 s58, s58, s55
    s_lshl_b32 s58, s58, 10
    s_lshl_b32 s84, s48, 15
    s_add_u32 s84, s84, s58
    s_add_u32 s84, s84, 262144
    s_lshl_b32 s57, s48, 7
    s_add_u32 s85, s58, s57
    s_lshl_b32 s85, s85, 5
    s_add_u32 s85, s85, 3146752
    s_lshl_b32 s58, s51, 9
    s_lshl_b32 s57, s48, 3
    s_add_u32 s58, s58, s57
    s_add_u32 s58, s58, s52
    s_lshl_b32 s86, s58, 8
    s_add_u32 s86, s86, 1048576
    s_add_u32 s87, s86, 65536
    s_lshr_b32 s88, s58, 3
    s_lshl_b32 s88, s88, 12
    s_lshl_b32 s57, s52, 4
    s_add_u32 s88, s88, s57
    s_add_u32 s88, s88, 3145728
    s_lshl_b32 s89, s53, 3
    s_add_u32 s89, s89, s55
    s_lshl_b32 s90, s89, 12
    s_add_u32 s90, s90, 3145728
    s_add_u32 s91, s90, 64
    s_lshl_b32 s89, s89, 11
    s_add_u32 s89, s89, 1048576
    s_mul_i32 s56, s52, 12
    s_sub_u32 s94, s88, s56
    s_mov_b32 s59, 0x3e0293ee
    s_add_u32 s60, s55, 9
    s_waitcnt lgkmcnt(0)
    s_and_b32 s56, s44, 0x7f7f7f7f
    s_add_u32 s56, s56, 0x01010101
    s_and_b32 s57, s44, 0x80808080
    s_xor_b32 s44, s56, s57
    s_lshr_b32 s45, s44, 8
    s_lshr_b32 s46, s44, 16
    s_lshr_b32 s47, s44, 24
    v_mov_b32 v14, s44
    s_cmp_lg_u32 s69, 0
    s_cbranch_scc1 L_nog
    s_waitcnt vmcnt(0)
    v_dot2_f32_bf16 v16, v32, v40, 0
    v_dot2_f32_bf16 v16, v33, v41, v16
    v_dot2_f32_bf16 v16, v34, v42, v16
    v_dot2_f32_bf16 v16, v35, v43, v16
    v_dot2_f32_bf16 v16, v36, v44, v16
    v_dot2_f32_bf16 v16, v37, v45, v16
    v_dot2_f32_bf16 v16, v38, v46, v16
    v_dot2_f32_bf16 v16, v39, v47, v16
    s_nop 2
    v_add_f32_dpp v16, v16, v16 row_ror:8 row_mask:0xf bank_mask:0xf
    s_nop 1
    v_add_f32_dpp v16, v16, v16 row_ror:4 row_mask:0xf bank_mask:0xf
    s_nop 1
    v_add_f32_dpp v16, v16, v16 row_ror:2 row_mask:0xf bank_mask:0xf
    s_nop 1
    v_add_f32_dpp v16, v16, v16 row_ror:1 row_mask:0xf bank_mask:0xf
    s_nop 1
    v_mov_b32 v7, v16
    s_nop 1
    v_permlane16_swap_b32 v16, v7
    v_add_f32 v16, v16, v7
    v_mov_b32 v7, v16
    s_nop 1
    v_permlane32_swap_b32 v16, v7
    v_add_f32 v16, v16, v7
    v_mul_f32 v16, 0xbfb8aa3b, v16
    v_exp_f32 v16, v16
    s_nop 0
    v_add_f32 v16, 1.0, v16
    v_rcp_f32 v16, v16
    v_mov_b32 v17, s44
    v_lshlrev_b32 v7, 8, v1
    s_lshl_b32 s56, s48, 3
    s_add_u32 s56, s56, 3148800
    buffer_store_dwordx2 v[16:17], v7, s[40:43], s56 offen sc1
L_nog:
    s_mov_b32 s64, 0
L_w41:
    ds_read_b32 v7, v4 offset:18376
    s_add_u32 s64, s64, 1
    s_waitcnt lgkmcnt(0)
    v_readfirstlane_b32 s56, v7
    s_cmp_ge_u32 s56, 4
    s_cbranch_scc1 L_wd42
    s_sleep 2
    s_cmp_lt_u32 s64, 1000000
    s_cbranch_scc1 L_w41
L_wd42:
    s_mov_b32 s64, 0
L_p43:
    s_load_dwordx16 s[4:19], s[40:41], s85 glc
    s_add_u32 s64, s64, 1
    s_cmp_ge_u32 s64, 100000
    s_waitcnt lgkmcnt(0)
    s_cbranch_scc1 L_pd44
    s_xor_b32 s56, s4, s44
    s_xor_b32 s57, s6, s44
    s_or_b32 s56, s56, s57
    s_xor_b32 s57, s8, s44
    s_or_b32 s56, s56, s57
    s_xor_b32 s57, s10, s44
    s_or_b32 s56, s56, s57
    s_xor_b32 s57, s12, s44
    s_or_b32 s56, s56, s57
    s_xor_b32 s57, s14, s44
    s_or_b32 s56, s56, s57
    s_xor_b32 s57, s16, s44
    s_or_b32 s56, s56, s57
    s_xor_b32 s57, s18, s44
    s_or_b32 s56, s56, s57
    s_cbranch_scc0 L_pd44
    s_cmp_gt_u32 s64, 99
    s_cbranch_scc1 L_p43
    s_sleep 3
    s_branch L_p43
L_pd44:
    buffer_load_dwordx4 v[64:67], v1, s[40:43], s84 offen sc1
    s_add_u32 s65, s5, s7
    s_add_u32 s65, s65, s9
    s_add_u32 s65, s65, s11
    s_add_u32 s65, s65, s13
    s_add_u32 s65, s65, s15
    s_add_u32 s65, s65, s17
    s_add_u32 s65, s65, s19
    s_mov_b32 s64, 0
L_w48:
    ds_read_b32 v7, v4 offset:18368
    s_add_u32 s64, s64, 1
    s_waitcnt lgkmcnt(0)
    v_readfirstlane_b32 s56, v7
    s_cmp_ge_u32 s56, s60
    s_cbranch_scc1 L_wd49
    s_sleep 1
    s_cmp_lt_u32 s64, 1000000
    s_cbranch_scc1 L_w48
L_wd49:
    ds_read_b128 v[32:35], v112
    ds_read_b128 v[36:39], v113
    ds_read_b128 v[40:43], v114
    ds_read_b128 v[44:47], v115
    s_mov_b32 s64, 0
    s_branch L_ce47
L_c45:
    s_sleep 4
    buffer_load_dwordx4 v[64:67], v1, s[40:43], s84 offen sc1
L_ce47:
    s_add_u32 s64, s64, 1
    s_waitcnt vmcnt(0)
    v_add3_u32 v7, v64, v65, v66
    v_add_u32 v7, v67, v7
    v_lshlrev_b32 v72, 16, v64
    v_and_b32 v73, s66, v64
    v_add_u32_dpp v7, v7, v7 row_ror:8 row_mask:0xf bank_mask:0xf
    v_lshlrev_b32 v74, 16, v65
    v_and_b32 v75, s66, v65
    v_add_u32_dpp v7, v7, v7 row_ror:4 row_mask:0xf bank_mask:0xf
    v_lshlrev_b32 v76, 16, v66
    v_and_b32 v77, s66, v66
    v_add_u32_dpp v7, v7, v7 row_ror:2 row_mask:0xf bank_mask:0xf
    v_lshlrev_b32 v78, 16, v67
    v_and_b32 v79, s66, v67
    v_add_u32_dpp v7, v7, v7 row_ror:1 row_mask:0xf bank_mask:0xf
    s_nop 0
    v_permlane32_swap_b32 v72, v76
    v_readlane_b32 s56, v7, 0
    v_readlane_b32 s57, v7, 16
    v_readlane_b32 s58, v7, 32
    v_readlane_b32 s49, v7, 48
    v_permlane32_swap_b32 v73, v77
    v_permlane32_swap_b32 v74, v78
    v_permlane32_swap_b32 v75, v79
    v_add_f32 v72, v72, v76
    v_add_f32 v74, v74, v78
    v_add_f32 v73, v73, v77
    v_add_f32 v75, v75, v79
    s_nop 0
    v_permlane16_swap_b32 v72, v74
    v_permlane16_swap_b32 v73, v75
    v_add_f32 v72, v72, v74
    v_add_f32 v73, v73, v75
    v_cvt_pk_bf16_f32 v72, v72, v73
    ds_write_b32 v116, v72 offset:4096
    s_add_u32 s56, s56, s57
    s_add_u32 s58, s58, s49
    s_add_u32 s56, s56, s58
    s_cmp_eq_u32 s56, s65
    s_cbranch_scc1 L_cd46
    s_cmp_lt_u32 s64, 100000
    s_cbranch_scc1 L_c45
L_cd46:
    s_mov_b64 exec, 1
    ds_add_u32 v4, v6 offset:18372
    s_mov_b64 exec, -1
    s_mov_b32 s64, 0
L_w50:
    ds_read_b64 v[16:17], v4 offset:18368
    s_add_u32 s64, s64, 1
    s_waitcnt lgkmcnt(0)
    v_readfirstlane_b32 s56, v17
    v_readfirstlane_b32 s61, v16
    s_cmp_ge_u32 s56, 8
    s_cbranch_scc1 L_wd51
    s_cmp_lt_u32 s64, 1000000
    s_cbranch_scc1 L_w50
L_wd51:
    ds_read_b128 v[48:51], v117 offset:4096
    ds_read_b128 v[52:55], v117 offset:4160
    ds_read_b128 v[56:59], v117 offset:4224
    ds_read_b128 v[60:63], v117 offset:4288
    s_waitcnt lgkmcnt(3)
    v_mfma_f32_16x16x32_bf16 v[96:99], v[32:35], v[48:51], 0
    s_waitcnt lgkmcnt(2)
    v_mfma_f32_16x16x32_bf16 v[96:99], v[36:39], v[52:55], v[96:99]
    s_waitcnt lgkmcnt(1)
    v_mfma_f32_16x16x32_bf16 v[96:99], v[40:43], v[56:59], v[96:99]
    s_waitcnt lgkmcnt(0)
    v_mfma_f32_16x16x32_bf16 v[96:99], v[44:47], v[60:63], v[96:99]
    s_cmp_lt_u32 s61, 24
    s_cbranch_scc1 L_vlate0
    ds_read_b64_tr_b16 v[64:65], v13 offset:0
    ds_read_b64_tr_b16 v[66:67], v13 offset:4096
    ds_read_b64_tr_b16 v[68:69], v13 offset:8192
    ds_read_b64_tr_b16 v[70:71], v13 offset:12288
    ds_read_b64_tr_b16 v[72:73], v13 offset:16384
    ds_read_b64_tr_b16 v[74:75], v13 offset:20480
    ds_read_b64_tr_b16 v[76:77], v13 offset:24576
    ds_read_b64_tr_b16 v[78:79], v13 offset:28672
    s_branch L_v0
L_vlate0:
    s_nop 5
L_v0:
    v_max_f32 v16, v96, v97
    v_max3_f32 v16, v98, v99, v16
    v_mov_b32 v7, v16
    s_nop 1
    v_permlane16_swap_b32 v16, v7
    v_max_f32 v16, v16, v7
    v_mov_b32 v7, v16
    s_nop 1
    v_permlane32_swap_b32 v16, v7
    v_max_f32 v16, v16, v7
    v_mul_f32 v16, s59, v16
    v_fma_f32 v96, v96, s59, -v16
    v_fma_f32 v97, v97, s59, -v16
    v_fma_f32 v98, v98, s59, -v16
    v_fma_f32 v99, v99, s59, -v16
    s_mov_b64 exec, 0xff
    ds_write_b32 v119, v16 offset:17824
    s_mov_b64 exec, -1
    v_exp_f32 v96, v96
    v_exp_f32 v97, v97
    v_exp_f32 v98, v98
    v_exp_f32 v99, v99
    v_cvt_pk_bf16_f32 v18, v96, v97
    v_add_f32 v17, v96, v97
    v_cvt_pk_bf16_f32 v19, v98, v99
    v_add_f32 v20, v98, v99
    s_mov_b64 exec, s[62:63]
    ds_write_b64 v118, v[18:19] offset:15616
    s_mov_b64 exec, 1
    ds_add_u32 v4, v6 offset:18372
    s_mov_b64 exec, -1
    v_add_f32 v17, v17, v20
    v_mov_b32 v20, v17
    s_nop 1
    v_permlane16_swap_b32 v17, v20
    v_add_f32 v17, v17, v20
    v_mov_b32 v20, v17
    s_nop 1
    v_permlane32_swap_b32 v17, v20
    v_add_f32 v17, v17, v20
    s_mov_b64 exec, 0xff
    ds_write_b32 v119, v17 offset:18080
    s_mov_b64 exec, -1
    v_mov_b32 v31, s44
    s_cmp_ge_u32 s61, 24
    s_cbranch_scc1 L_v1
    s_mov_b32 s64, 0
L_w52:
    ds_read_b32 v7, v4 offset:18368
    s_add_u32 s64, s64, 1
    s_waitcnt lgkmcnt(0)
    v_readfirstlane_b32 s56, v7
    s_cmp_ge_u32 s56, 24
    s_cbranch_scc1 L_wd53
    s_cmp_lt_u32 s64, 1000000
    s_cbranch_scc1 L_w52
L_wd53:
    ds_read_b64_tr_b16 v[64:65], v13 offset:0
    ds_read_b64_tr_b16 v[66:67], v13 offset:4096
    ds_read_b64_tr_b16 v[68:69], v13 offset:8192
    ds_read_b64_tr_b16 v[70:71], v13 offset:12288
    ds_read_b64_tr_b16 v[72:73], v13 offset:16384
    ds_read_b64_tr_b16 v[74:75], v13 offset:20480
    ds_read_b64_tr_b16 v[76:77], v13 offset:24576
    ds_read_b64_tr_b16 v[78:79], v13 offset:28672
L_v1:
    s_mov_b32 s64, 0
L_w54:
    ds_read_b32 v7, v4 offset:18372
    s_add_u32 s64, s64, 1
    s_waitcnt lgkmcnt(0)
    v_readfirstlane_b32 s56, v7
    s_cmp_ge_u32 s56, 16
    s_cbranch_scc1 L_wd55
    s_cmp_lt_u32 s64, 1000000
    s_cbranch_scc1 L_w54
L_wd55:
    ds_read_b128 v[80:83], v120
    ds_read_b128 v[48:51], v122 offset:17824
    ds_read_b128 v[52:55], v123 offset:17824
    ds_read_b128 v[84:87], v120 offset:16
    ds_read_b128 v[88:91], v121
    ds_read_b128 v[92:95], v121 offset:16
    s_waitcnt lgkmcnt(5)
    v_mfma_f32_16x16x16_bf16 v[96:99], v[64:65], v[80:81], 0
    v_mfma_f32_16x16x16_bf16 v[100:103], v[66:67], v[82:83], 0
    s_waitcnt lgkmcnt(2)
    v_mfma_f32_16x16x16_bf16 v[104:107], v[68:69], v[84:85], 0
    v_max3_f32 v28, v48, v49, v50
    v_max3_f32 v28, v51, v52, v28
    v_mfma_f32_16x16x16_bf16 v[108:111], v[70:71], v[86:87], 0
    v_max3_f32 v28, v53, v54, v28
    v_max_f32 v28, v55, v28
    s_waitcnt lgkmcnt(1)
    v_mfma_f32_16x16x16_bf16 v[96:99], v[72:73], v[88:89], v[96:99]
    v_sub_f32 v48, v48, v28
    v_sub_f32 v49, v49, v28
    v_mfma_f32_16x16x16_bf16 v[100:103], v[74:75], v[90:91], v[100:103]
    v_sub_f32 v50, v50, v28
    v_sub_f32 v51, v51, v28
    s_waitcnt lgkmcnt(0)
    v_mfma_f32_16x16x16_bf16 v[104:107], v[76:77], v[92:93], v[104:107]
    v_exp_f32 v48, v48
    v_exp_f32 v49, v49
    v_mfma_f32_16x16x16_bf16 v[108:111], v[78:79], v[94:95], v[108:111]
    v_exp_f32 v50, v50
    v_exp_f32 v51, v51
    v_mul_f32 v96, v48, v96
    v_mul_f32 v97, v48, v97
    v_mul_f32 v98, v48, v98
    v_mul_f32 v99, v48, v99
    v_fmac_f32 v96, v49, v100
    v_fmac_f32 v97, v49, v101
    v_fmac_f32 v98, v49, v102
    v_fmac_f32 v99, v49, v103
    v_fmac_f32 v96, v50, v104
    v_fmac_f32 v97, v50, v105
    v_fmac_f32 v98, v50, v106
    v_fmac_f32 v99, v50, v107
    v_fmac_f32 v96, v51, v108
    v_fmac_f32 v97, v51, v109
    v_fmac_f32 v98, v51, v110
    v_fmac_f32 v99, v51, v111
    v_add_f32_dpp v96, v96, v96 row_ror:8 row_mask:0xf bank_mask:0xf
    v_add_f32_dpp v97, v97, v97 row_ror:8 row_mask:0xf bank_mask:0xf
    v_add_f32_dpp v98, v98, v98 row_ror:8 row_mask:0xf bank_mask:0xf
    v_add_f32_dpp v99, v99, v99 row_ror:8 row_mask:0xf bank_mask:0xf
    s_mov_b64 exec, s[62:63]
    v_cvt_pk_bf16_f32 v96, v96, v97
    v_cvt_pk_bf16_f32 v97, v98, v99
    ds_write_b64 v124, v[96:97] offset:11008
    v_add_u32 v98, v96, v97
    ds_add_u32 v8, v98 offset:18464
    s_mov_b64 exec, 1
    ds_add_rtn_u32 v7, v4, v6 offset:18392
    s_mov_b64 exec, -1
    ds_read_b128 v[32:35], v125 offset:11008
    ds_read_b128 v[36:39], v125 offset:12160
    ds_read_b128 v[56:59], v122 offset:18080
    ds_read_b32 v30, v8 offset:18464
    s_waitcnt lgkmcnt(4)
    v_readfirstlane_b32 s56, v7
    s_cmp_lg_u32 s56, 7
    s_cbranch_scc1 L_noml
    s_waitcnt lgkmcnt(2)
    buffer_store_dwordx4 v[32:35], v126, s[40:43], s86 offen sc1
    buffer_store_dwordx4 v[36:39], v126, s[40:43], s87 offen sc1
    s_waitcnt lgkmcnt(0)
    v_mul_f32 v29, v48, v56
    v_fmac_f32 v29, v49, v57
    v_fmac_f32 v29, v50, v58
    v_fmac_f32 v29, v51, v59
    s_nop 1
    v_add_f32_dpp v29, v29, v29 row_ror:8 row_mask:0xf bank_mask:0xf
    s_mov_b64 exec, 0xff
    buffer_store_dwordx4 v[28:31], v127, s[40:43], s88 offen sc1
    s_mov_b64 exec, -1
L_noml:
    s_mov_b32 s64, 0
L_w56:
    ds_read_b32 v7, v4 offset:18392
    s_add_u32 s64, s64, 1
    s_waitcnt lgkmcnt(0)
    v_readfirstlane_b32 s56, v7
    s_cmp_ge_u32 s56, 8
    s_cbranch_scc1 L_wd57
    s_cmp_lt_u32 s64, 1000000
    s_cbranch_scc1 L_w56
L_wd57:
    s_mov_b32 s64, 0
L_p58:
    s_load_dwordx16 s[4:19], s[40:41], s90 glc
    s_load_dwordx16 s[20:35], s[40:41], s91 glc
    s_add_u32 s64, s64, 1
    s_cmp_ge_u32 s64, 100000
    s_waitcnt lgkmcnt(0)
    s_cbranch_scc1 L_pd59
    s_xor_b32 s56, s7, s44
    s_xor_b32 s57, s11, s44
    s_or_b32 s56, s56, s57
    s_xor_b32 s57, s15, s44
    s_or_b32 s56, s56, s57
    s_xor_b32 s57, s19, s44
    s_or_b32 s56, s56, s57
    s_xor_b32 s57, s23, s44
    s_or_b32 s56, s56, s57
    s_xor_b32 s57, s27, s44
    s_or_b32 s56, s56, s57
    s_xor_b32 s57, s31, s44
    s_or_b32 s56, s56, s57
    s_xor_b32 s57, s35, s44
    s_or_b32 s56, s56, s57
    s_cbranch_scc0 L_pd59
    s_cmp_gt_u32 s64, 99
    s_cbranch_scc1 L_p58
    s_sleep 3
    s_branch L_p58
L_pd59:
    buffer_load_dwordx4 v[64:67], v1, s[40:43], s89 offen offset:0 sc1
    buffer_load_dwordx4 v[68:71], v1, s[40:43], s89 offen offset:1024 sc1
    s_add_u32 s65, s6, s10
    s_add_u32 s65, s65, s14
    s_add_u32 s65, s65, s18
    s_add_u32 s65, s65, s22
    s_add_u32 s65, s65, s26
    s_add_u32 s65, s65, s30
    s_add_u32 s65, s65, s34
    s_mov_b32 s64, 0
L_w63:
    ds_read_b32 v7, v4 offset:18496
    s_add_u32 s64, s64, 1
    s_waitcnt lgkmcnt(0)
    v_readfirstlane_b32 s56, v7
    s_cmp_ge_u32 s56, 1
    s_cbranch_scc1 L_wd64
    s_cmp_lt_u32 s64, 1000000
    s_cbranch_scc1 L_w63
L_wd64:
    ds_read_b32 v92, v25 offset:18336
    v_mov_b32 v90, s4
    v_max_f32 v90, s8, v90
    v_max_f32 v90, s12, v90
    v_max_f32 v90, s16, v90
    v_max_f32 v90, s20, v90
    v_max_f32 v90, s24, v90
    v_max_f32 v90, s28, v90
    v_max_f32 v90, s32, v90
    v_sub_f32 v16, s4, v90
    v_sub_f32 v17, s8, v90
    v_sub_f32 v18, s12, v90
    v_sub_f32 v19, s16, v90
    v_sub_f32 v20, s20, v90
    v_sub_f32 v21, s24, v90
    v_sub_f32 v22, s28, v90
    v_sub_f32 v23, s32, v90
    v_exp_f32 v16, v16
    v_exp_f32 v17, v17
    v_exp_f32 v18, v18
    v_exp_f32 v19, v19
    v_exp_f32 v20, v20
    v_exp_f32 v21, v21
    v_exp_f32 v22, v22
    v_exp_f32 v23, v23
    v_mul_f32 v91, s5, v16
    v_fmac_f32 v91, s9, v17
    v_fmac_f32 v91, s13, v18
    v_fmac_f32 v91, s17, v19
    v_fmac_f32 v91, s21, v20
    v_fmac_f32 v91, s25, v21
    v_fmac_f32 v91, s29, v22
    v_fmac_f32 v91, s33, v23
    v_rcp_f32 v91, v91
    s_mov_b32 exec_lo, 0xffff
    s_mov_b32 exec_hi, 0x0
    v_mov_b32 v88, v16
    v_mov_b32 v89, v20
    s_mov_b32 exec_lo, 0xffff0000
    s_mov_b32 exec_hi, 0x0
    v_mov_b32 v88, v17
    v_mov_b32 v89, v21
    s_mov_b32 exec_lo, 0x0
    s_mov_b32 exec_hi, 0xffff
    v_mov_b32 v88, v18
    v_mov_b32 v89, v22
    s_mov_b32 exec_lo, 0x0
    s_mov_b32 exec_hi, 0xffff0000
    v_mov_b32 v88, v19
    v_mov_b32 v89, v23
    s_mov_b64 exec, -1
    s_waitcnt lgkmcnt(0)
    v_mul_f32 v91, v92, v91
    v_mul_f32 v88, v88, v91
    v_mul_f32 v89, v89, v91
    ds_read_b32 v7, v4 offset:18368
    s_waitcnt lgkmcnt(0)
    v_readfirstlane_b32 s61, v7
    s_cmp_lt_u32 s61, 40
    s_cbranch_scc1 L_olate
    ds_read_b64_tr_b16 v[32:33], v12 offset:0
    ds_read_b64_tr_b16 v[34:35], v12 offset:4096
    ds_read_b64_tr_b16 v[36:37], v12 offset:8192
    ds_read_b64_tr_b16 v[38:39], v12 offset:12288
    ds_read_b64_tr_b16 v[40:41], v12 offset:16384
    ds_read_b64_tr_b16 v[42:43], v12 offset:20480
    ds_read_b64_tr_b16 v[44:45], v12 offset:24576
    ds_read_b64_tr_b16 v[46:47], v12 offset:28672
L_olate:
    s_mov_b32 s64, 0
    s_branch L_ce62
L_c60:
    s_sleep 4
    buffer_load_dwordx4 v[64:67], v1, s[40:43], s89 offen offset:0 sc1
    buffer_load_dwordx4 v[68:71], v1, s[40:43], s89 offen offset:1024 sc1
L_ce62:
    s_add_u32 s64, s64, 1
    s_waitcnt vmcnt(0)
    v_add3_u32 v7, v64, v65, v66
    v_add3_u32 v7, v67, v68, v7
    v_add3_u32 v7, v69, v70, v7
    v_add_u32 v7, v71, v7
    v_lshlrev_b32 v72, 16, v64
    v_and_b32 v73, s66, v64
    v_add_u32_dpp v7, v7, v7 row_ror:8 row_mask:0xf bank_mask:0xf
    v_lshlrev_b32 v74, 16, v65
    v_and_b32 v75, s66, v65
    v_add_u32_dpp v7, v7, v7 row_ror:4 row_mask:0xf bank_mask:0xf
    v_lshlrev_b32 v76, 16, v66
    v_and_b32 v77, s66, v66
    v_add_u32_dpp v7, v7, v7 row_ror:2 row_mask:0xf bank_mask:0xf
    v_lshlrev_b32 v78, 16, v67
    v_and_b32 v79, s66, v67
    v_add_u32_dpp v7, v7, v7 row_ror:1 row_mask:0xf bank_mask:0xf
    v_lshlrev_b32 v80, 16, v68
    v_and_b32 v81, s66, v68
    v_readlane_b32 s56, v7, 0
    v_readlane_b32 s57, v7, 16
    v_readlane_b32 s58, v7, 32
    v_readlane_b32 s49, v7, 48
    v_lshlrev_b32 v82, 16, v69
    v_and_b32 v83, s66, v69
    v_lshlrev_b32 v84, 16, v70
    v_and_b32 v85, s66, v70
    v_lshlrev_b32 v86, 16, v71
    v_and_b32 v87, s66, v71
    v_mul_f32 v72, v88, v72
    v_mul_f32 v73, v88, v73
    v_mul_f32 v74, v88, v74
    v_mul_f32 v75, v88, v75
    v_mul_f32 v76, v88, v76
    v_mul_f32 v77, v88, v77
    v_mul_f32 v78, v88, v78
    v_mul_f32 v79, v88, v79
    v_fmac_f32 v72, v89, v80
    v_fmac_f32 v76, v89, v84
    v_fmac_f32 v73, v89, v81
    v_fmac_f32 v77, v89, v85
    v_fmac_f32 v74, v89, v82
    v_fmac_f32 v78, v89, v86
    v_fmac_f32 v75, v89, v83
    v_fmac_f32 v79, v89, v87
    v_permlane32_swap_b32 v72, v76
    v_permlane32_swap_b32 v73, v77
    v_permlane32_swap_b32 v74, v78
    s_nop 0
    v_permlane32_swap_b32 v75, v79
    v_add_f32 v72, v72, v76
    v_add_f32 v74, v74, v78
    v_add_f32 v73, v73, v77
    v_add_f32 v75, v75, v79
    s_nop 0
    v_permlane16_swap_b32 v72, v74
    v_permlane16_swap_b32 v73, v75
    v_add_f32 v72, v72, v74
    v_add_f32 v73, v73, v75
    v_cvt_pk_bf16_f32 v72, v72, v73
    ds_write_b32 v24, v72 offset:8704
    s_add_u32 s56, s56, s57
    s_add_u32 s58, s58, s49
    s_add_u32 s56, s56, s58
    s_cmp_eq_u32 s56, s65
    s_cbranch_scc1 L_cd61
    s_cmp_lt_u32 s64, 100000
    s_cbranch_scc1 L_c60
L_cd61:
    s_mov_b64 exec, 1
    ds_add_u32 v4, v6 offset:18372
    s_mov_b64 exec, -1
    s_cmp_ge_u32 s61, 40
    s_cbranch_scc1 L_ohave
    s_mov_b32 s64, 0
L_w65:
    ds_read_b32 v7, v4 offset:18368
    s_add_u32 s64, s64, 1
    s_waitcnt lgkmcnt(0)
    v_readfirstlane_b32 s56, v7
    s_cmp_ge_u32 s56, 40
    s_cbranch_scc1 L_wd66
    s_cmp_lt_u32 s64, 1000000
    s_cbranch_scc1 L_w65
L_wd66:
    ds_read_b64_tr_b16 v[32:33], v12 offset:0
    ds_read_b64_tr_b16 v[34:35], v12 offset:4096
    ds_read_b64_tr_b16 v[36:37], v12 offset:8192
    ds_read_b64_tr_b16 v[38:39], v12 offset:12288
    ds_read_b64_tr_b16 v[40:41], v12 offset:16384
    ds_read_b64_tr_b16 v[42:43], v12 offset:20480
    ds_read_b64_tr_b16 v[44:45], v12 offset:24576
    ds_read_b64_tr_b16 v[46:47], v12 offset:28672
L_ohave:
    s_mov_b32 s64, 0
L_w67:
    ds_read_b32 v7, v4 offset:18372
    ds_read_b128 v[48:51], v117 offset:8704
    ds_read_b128 v[52:55], v117 offset:8768
    ds_read_b128 v[56:59], v117 offset:8832
    ds_read_b128 v[60:63], v117 offset:8896
    s_add_u32 s64, s64, 1
    s_waitcnt lgkmcnt(4)
    v_readfirstlane_b32 s56, v7
    s_cmp_ge_u32 s56, 24
    s_cbranch_scc1 L_wd68
    s_cmp_lt_u32 s64, 1000000
    s_cbranch_scc1 L_w67
L_wd68:
    s_waitcnt lgkmcnt(3)
    v_mfma_f32_16x16x32_bf16 v[96:99], v[32:35], v[48:51], 0
    s_waitcnt lgkmcnt(2)
    v_mfma_f32_16x16x32_bf16 v[96:99], v[36:39], v[52:55], v[96:99]
    s_waitcnt lgkmcnt(1)
    v_mfma_f32_16x16x32_bf16 v[96:99], v[40:43], v[56:59], v[96:99]
    s_waitcnt lgkmcnt(0)
    v_mfma_f32_16x16x32_bf16 v[96:99], v[44:47], v[60:63], v[96:99]
    s_mov_b64 exec, s[62:63]
    s_nop 6
    ds_write_b128 v15, v[96:99] offset:18512
    s_mov_b64 exec, 1
    v_lshlrev_b32 v7, s93, v6
    ds_add_rtn_u32 v7, v4, v7 offset:18396
    s_mov_b64 exec, -1
    ds_read_b128 v[64:67], v27 offset:18512
    ds_read_b128 v[68:71], v27 offset:22736
    s_add_u32 s57, s68, 1
    s_waitcnt lgkmcnt(2)
    v_readfirstlane_b32 s56, v7
    s_lshr_b32 s56, s56, s93
    s_and_b32 s56, s56, 0xff
    s_cmp_lg_u32 s56, s57
    s_cbranch_scc1 L_end
    s_cmp_eq_u32 s68, 0
    s_waitcnt lgkmcnt(0)
    s_cbranch_scc1 L_rz69
    v_add_f32 v64, v64, v68
    v_add_f32 v65, v65, v69
    v_add_f32 v66, v66, v70
    v_add_f32 v67, v67, v71
L_rz69:
    v_bfi_b32 v64, v5, s44, v64
    v_bfi_b32 v65, v5, s45, v65
    v_bfi_b32 v66, v5, s46, v66
    v_bfi_b32 v67, v5, s47, v67
    buffer_store_dwordx4 v[64:67], v26, s[40:43], s92 offen sc1
    s_mov_b64 exec, 1
    v_mov_b32 v7, 2
    ds_add_u32 v4, v7 offset:18372
    s_mov_b64 exec, -1
L_end:
    s_endpgm
.fill (14336 + 256 - (. - gated_mix__sliding_block_cached__dense_activation_relu__decode_kernel)) / 4, 4, 0xBF810000
.section .rodata,"a"
.p2align 6
.amdhsa_kernel gated_mix__sliding_block_cached__dense_activation_relu__decode_kernel
  .amdhsa_next_free_vgpr 128
  .amdhsa_next_free_sgpr 102
  .amdhsa_accum_offset 128
  .amdhsa_group_segment_fixed_size 0
  .amdhsa_kernarg_size 96
  .amdhsa_user_sgpr_count 2
  .amdhsa_user_sgpr_kernarg_segment_ptr 1
  .amdhsa_system_sgpr_workgroup_id_x 1
  .amdhsa_float_denorm_mode_32 3
.end_amdhsa_kernel
```
